```python
import torch

def _softmax(x, axis=-1):
    return torch.softmax(x, dim=axis)
def _gelu(x):
    return torch.nn.functional.gelu(x, approximate="tanh")
def _silu(x):
    return torch.nn.functional.silu(x)
def _sigmoid(x):
    return torch.sigmoid(x)
def _layernorm(x, axis=-1, eps=1e-5):
    m = x.mean(dim=axis, keepdim=True)
    v = x.var(dim=axis, keepdim=True, unbiased=False)
    return (x - m) / torch.sqrt(v + eps)
def _scatter_add(tgt, idx, src, axis=0):
    return tgt.clone().index_add_(axis, idx, src)
def _segment_sum(src, seg, n):
    out = torch.zeros((n,) + src.shape[1:], dtype=src.dtype)
    return out.index_add_(0, seg, src)
def _pad(x, pw):
    flat = tuple(v for pair in reversed(pw) for v in pair)
    return torch.nn.functional.pad(x, flat)

kernel_name = 'standalone__modern_conv_block_replknet__vision'

def setup_inputs():

    _w = (lambda a: (lambda t: t.to(torch.bfloat16) if t.is_floating_point() else t)(torch.as_tensor(a)))
    H = W = 384
    C = 96
    K = 3
    return {
        "x": _w((lambda *s: torch.randn(*s, dtype=torch.bfloat16) * 0.05)(1, H, W, C)),
        "dw_large": _w((lambda *s: torch.randn(*s, dtype=torch.bfloat16) * 0.4)(K, K, C) * (1.0 / K)),
        "dw_small": _w((lambda *s: torch.randn(*s, dtype=torch.bfloat16) * 0.4)(5, 5, C) * 0.2),
        "w1": _w((lambda *s: torch.randn(*s, dtype=torch.bfloat16) * 0.4)(C, 4 * C) * (C ** -0.5)),
        "w2": _w((lambda *s: torch.randn(*s, dtype=torch.bfloat16) * 0.1)(4 * C, C) * ((4 * C) ** -0.5)),
    }

def reference(x, dw_large, dw_small, w1, w2):
    B, H, W, C = x.shape
    Kl = dw_large.shape[0]
    pl = (Kl - 1) // 2
    xpl = _pad(x, ((0,0),(pl,pl),(pl,pl),(0,0)))
    out = torch.zeros_like(x)
    for i in range(Kl):
        for j in range(Kl):
            out = out + xpl[:, i:i+H, j:j+W, :] * dw_large[i, j][None, None, None, :]
    Ks = dw_small.shape[0]
    ps = (Ks - 1) // 2
    xps = _pad(x, ((0,0),(ps,ps),(ps,ps),(0,0)))
    for i in range(Ks):
        for j in range(Ks):
            out = out + xps[:, i:i+H, j:j+W, :] * dw_small[i, j][None, None, None, :]
    h = _layernorm(out, axis=-1)
    h = _gelu(torch.einsum('bhwc,ce->bhwe', h, w1))
    h = torch.einsum('bhwe,ec->bhwc', h, w2)
    return x + h
```

```asm
; @launch grid=(256,1,1) block=(512,1,1) lds=163840
.amdgcn_target "amdgcn-amd-amdhsa--gfx950"
.text
.globl standalone__modern_conv_block_replknet__vision_kernel
.p2align 8
.type standalone__modern_conv_block_replknet__vision_kernel,@function
standalone__modern_conv_block_replknet__vision_kernel:
  s_cmp_ge_u32 s2, 256
  s_cbranch_scc1 L_end
  s_load_dwordx2 s[4:5], s[0:1], 0
  s_load_dwordx4 s[24:27], s[0:1], 8
  s_load_dwordx4 s[96:99], s[0:1], 24
  s_load_dwordx2 s[8:9], s[0:1], 40
  s_getpc_b64 s[52:53]
L_pc:
  v_lshlrev_b32 v5, 7, v0
  v_min_u32 v5, L_end-L_pc, v5
  global_load_dword v255, v5, s[52:53]
  s_mov_b32 s6, 28311552
  s_mov_b32 s7, 0x20000
  v_lshrrev_b32 v5, 6, v0
  v_and_b32 v6, 63, v0
  v_readfirstlane_b32 s28, v5
  v_lshlrev_b32 v4, 4, v6
  s_lshr_b32 s29, s2, 3
  s_and_b32 s3, s2, 7
  s_mul_i32 s3, s3, 6
  s_and_b32 s19, s28, 3
  s_lshl_b32 s58, s19, 10
  v_mov_b32 v14, 0
  s_mul_i32 s31, s29, 171
  s_lshr_b32 s31, s31, 10
  s_mul_i32 s32, s31, 6
  s_sub_u32 s32, s29, s32
  s_add_u32 s32, s32, s3
  s_mul_i32 s34, s31, 1179648
  s_mul_i32 s33, s32, 1536
  s_add_u32 s34, s34, s33
  s_cmp_eq_u32 s32, 0
  s_cselect_b32 s39, 0, 8
  s_cmp_eq_u32 s32, 47
  s_cselect_b32 s39, 4, s39
  s_cmp_ge_u32 s28, 4
  s_cbranch_scc1 L_grpB
  v_subrev_u32 v6, 192, v4
  s_movk_i32 s30, 576
  v_cmp_gt_u32 s[32:33], s30, v6
  s_cmp_eq_u32 s28, 0
  s_cselect_b64 s[30:31], -1, 0
  v_cndmask_b32 v6, -1, v6, s[32:33]
  v_cndmask_b32 v6, v6, v4, s[30:31]
  s_mov_b32 s30, 71408
  s_movk_i32 s31, 1338
  v_and_b32 v5, 255, v0
  v_mul_u32_u24 v7, 7232, v5
  v_lshrrev_b32 v7, 20, v7
  v_mul_u32_u24 v8, 145, v7
  v_sub_u32 v8, v5, v8
  v_lshlrev_b32 v5, 4, v5
  v_mad_u32_u24 v138, v7, s30, v5
  v_mad_u32_u24 v7, v8, s31, s31
  v_lshrrev_b32 v7, 16, v7
  v_mad_i32_i24 v138, v7, -8, v138
  v_subrev_u32 v7, 24, v8
  v_lshrrev_b32 v7, 31, v7
  v_lshl_or_b32 v14, v7, 0, v14
  v_sub_u32 v7, 120, v8
  v_lshrrev_b32 v7, 31, v7
  v_lshl_or_b32 v14, v7, 4, v14
  v_and_b32 v5, 255, v0
  v_add_u32 v5, 256, v5
  v_mul_u32_u24 v7, 7232, v5
  v_lshrrev_b32 v7, 20, v7
  v_mul_u32_u24 v8, 145, v7
  v_sub_u32 v8, v5, v8
  v_lshlrev_b32 v5, 4, v5
  v_mad_u32_u24 v139, v7, s30, v5
  v_mad_u32_u24 v7, v8, s31, s31
  v_lshrrev_b32 v7, 16, v7
  v_mad_i32_i24 v139, v7, -8, v139
  v_subrev_u32 v7, 24, v8
  v_lshrrev_b32 v7, 31, v7
  v_lshl_or_b32 v14, v7, 1, v14
  v_sub_u32 v7, 120, v8
  v_lshrrev_b32 v7, 31, v7
  v_lshl_or_b32 v14, v7, 5, v14
  s_sub_u32 s48, s34, 147840
  s_add_u32 s49, s58, 47104
  v_lshrrev_b32 v8, s39, v14
  v_bfe_i32 v200, v8, 0, 1
  v_add_u32 v204, s48, v138
  v_or_b32 v204, v204, v200
  v_or_b32 v200, v200, v138
  v_bfe_i32 v201, v8, 1, 1
  v_add_u32 v205, s48, v139
  v_or_b32 v205, v205, v201
  v_or_b32 v201, v201, v139
  s_waitcnt lgkmcnt(0)
  s_mov_b32 s20, s26
  s_mov_b32 s21, s27
  s_movk_i32 s22, 4800
  s_mov_b32 s23, 0x20000
  s_add_u32 m0, s58, 106496
  s_mul_i32 s30, s19, 576
  buffer_load_dwordx4 v4, s[20:23], s58 offen lds
  s_mul_i32 s31, s19, 960
  s_sub_u32 s30, s30, 576
  s_add_u32 s31, s31, 111616
  s_cmp_eq_u32 s28, 0
  s_cselect_b32 s20, s26, s24
  s_cselect_b32 s21, s27, s25
  s_cselect_b32 s22, s22, 1728
  s_cselect_b32 m0, 110592, s31
  s_cselect_b32 s30, 4096, s30
  buffer_load_dwordx4 v6, s[20:23], s30 offen lds
  s_add_u32 m0, s49, 0
  s_nop 0
  buffer_load_dwordx4 v204, s[4:7], 0 offen lds
  s_add_u32 m0, s49, 4096
  s_nop 0
  buffer_load_dwordx4 v205, s[4:7], 0 offen lds
  s_add_u32 m0, s49, 16240
  s_add_u32 s31, s48, 516096
  buffer_load_dwordx4 v200, s[4:7], s31 offen lds
  s_add_u32 m0, s49, 20336
  s_add_u32 s31, s48, 516096
  buffer_load_dwordx4 v201, s[4:7], s31 offen lds
  s_add_u32 m0, s49, 32480
  s_add_u32 s31, s48, 1032192
  buffer_load_dwordx4 v200, s[4:7], s31 offen lds
  s_add_u32 m0, s49, 36576
  s_add_u32 s31, s48, 1032192
  buffer_load_dwordx4 v201, s[4:7], s31 offen lds
  v_pk_mov_b32 v[64:65], 0, 0
  v_pk_mov_b32 v[76:77], 0, 0
  v_pk_mov_b32 v[88:89], 0, 0
  v_pk_mov_b32 v[100:101], 0, 0
  v_pk_mov_b32 v[112:113], 0, 0
  v_pk_mov_b32 v[124:125], 0, 0
  v_pk_mov_b32 v[136:137], 0, 0
  v_bfe_u32 v5, v0, 3, 3
  v_and_b32 v7, 3, v0
  v_sub_u32 v5, v5, v7
  v_cmp_gt_u32 s[32:33], 5, v5
  v_mul_u32_u24 v5, 192, v5
  v_bfe_u32 v7, v0, 2, 1
  s_movk_i32 s30, 5120
  v_mad_u32_u24 v5, v7, s30, v5
  v_mov_b32 v7, s30
  v_cndmask_b32 v5, v7, v5, s[32:33]
  s_mul_i32 s30, s19, 48
  s_add_u32 s30, s30, 106496
  v_add_u32 v192, s30, v5
  v_mfma_f32_32x32x8_bf16 v[144:159], v[64:65], v[64:65], 0
  v_mfma_f32_32x32x8_bf16 v[160:175], v[64:65], v[64:65], 0
  v_mfma_f32_32x32x8_bf16 v[176:191], v[64:65], v[64:65], 0
  v_add_u32 v143, 100352, v4
  s_call_b64 s[24:25], L_setupc
  v_add_u32 v142, 47104, v9
  s_waitcnt vmcnt(6)
  s_barrier
  s_call_b64 s[24:25], L_setup
  s_mov_b32 s30, 71408
  s_movk_i32 s31, 1338
  v_and_b32 v5, 255, v0
  v_add_u32 v5, 512, v5
  v_mul_u32_u24 v7, 7232, v5
  v_lshrrev_b32 v7, 20, v7
  v_mul_u32_u24 v8, 145, v7
  v_sub_u32 v8, v5, v8
  v_lshlrev_b32 v5, 4, v5
  v_mad_u32_u24 v140, v7, s30, v5
  v_mad_u32_u24 v7, v8, s31, s31
  v_lshrrev_b32 v7, 16, v7
  v_mad_i32_i24 v140, v7, -8, v140
  v_subrev_u32 v7, 24, v8
  v_lshrrev_b32 v7, 31, v7
  v_lshl_or_b32 v14, v7, 2, v14
  v_sub_u32 v7, 120, v8
  v_lshrrev_b32 v7, 31, v7
  v_lshl_or_b32 v14, v7, 6, v14
  v_and_b32 v5, 255, v0
  v_add_u32 v5, 768, v5
  v_mul_u32_u24 v7, 7232, v5
  v_lshrrev_b32 v7, 20, v7
  v_mul_u32_u24 v8, 145, v7
  v_sub_u32 v8, v5, v8
  v_lshlrev_b32 v5, 4, v5
  v_mad_u32_u24 v141, v7, s30, v5
  v_mad_u32_u24 v7, v8, s31, s31
  v_lshrrev_b32 v7, 16, v7
  v_mad_i32_i24 v141, v7, -8, v141
  v_subrev_u32 v7, 24, v8
  v_lshrrev_b32 v7, 31, v7
  v_lshl_or_b32 v14, v7, 3, v14
  v_sub_u32 v7, 120, v8
  v_lshrrev_b32 v7, 31, v7
  v_lshl_or_b32 v14, v7, 7, v14
  s_call_b64 s[24:25], L_setup2
  s_waitcnt vmcnt(0) lgkmcnt(0)
  s_barrier
  s_call_b64 s[24:25], L_core
  v_add_u32 v8, 47104, v15
  ds_read_b64 v[208:209], v8 offset:0
  ds_read_b64 v[210:211], v8 offset:8
  ds_read_b64 v[212:213], v8 offset:32
  ds_read_b64 v[214:215], v8 offset:40
  ds_read_b64 v[216:217], v8 offset:64
  ds_read_b64 v[218:219], v8 offset:72
  ds_read_b64 v[220:221], v8 offset:96
  ds_read_b64 v[222:223], v8 offset:104
  ds_read_b64 v[224:225], v8 offset:128
  ds_read_b64 v[226:227], v8 offset:136
  ds_read_b64 v[228:229], v8 offset:160
  ds_read_b64 v[230:231], v8 offset:168
  s_call_b64 s[24:25], L_stats
  s_sub_u32 s48, s37, 147840
  s_add_u32 s49, s58, 47104
  v_lshrrev_b32 v8, s42, v14
  v_bfe_i32 v200, v8, 0, 1
  v_add_u32 v204, s48, v138
  v_or_b32 v204, v204, v200
  v_or_b32 v200, v200, v138
  v_bfe_i32 v201, v8, 1, 1
  v_add_u32 v205, s48, v139
  v_or_b32 v205, v205, v201
  v_or_b32 v201, v201, v139
  v_bfe_i32 v202, v8, 2, 1
  v_add_u32 v206, s48, v140
  v_or_b32 v206, v206, v202
  v_or_b32 v202, v202, v140
  v_bfe_i32 v203, v8, 3, 1
  v_add_u32 v207, s48, v141
  v_or_b32 v207, v207, v203
  v_or_b32 v203, v203, v141
  s_barrier
  s_setprio 2
  ds_read_b128 v[40:43], v143 offset:0
  ds_read_b128 v[44:47], v143 offset:1024
  ds_read_b128 v[48:51], v143 offset:2048
  ds_read_b128 v[52:55], v143 offset:3072
  s_mov_b32 s27, 0
  s_setprio 0
  v_add_u32 v5, 75776, v10
  s_call_b64 s[24:25], L_normd
  v_mfma_f32_32x32x8_bf16 v[144:159], v[64:65], v[64:65], 0
  v_mfma_f32_32x32x8_bf16 v[160:175], v[64:65], v[64:65], 0
  v_mfma_f32_32x32x8_bf16 v[176:191], v[64:65], v[64:65], 0
  v_add_u32 v142, 0, v9
  s_mov_b32 s26, 1
  s_barrier
  v_add_u32 v8, 75776, v12
  ds_read_b128 v[16:19], v8 offset:0
  ds_read_b128 v[20:23], v8 offset:1024
  ds_read_b128 v[24:27], v8 offset:2048
  ds_read_b128 v[28:31], v8 offset:3072
  ds_read_b128 v[32:35], v8 offset:4096
  ds_read_b128 v[36:39], v8 offset:5120
  s_call_b64 s[24:25], L_core
  v_add_u32 v8, 0, v15
  ds_read_b64 v[232:233], v8 offset:0
  ds_read_b64 v[234:235], v8 offset:8
  ds_read_b64 v[236:237], v8 offset:32
  ds_read_b64 v[238:239], v8 offset:40
  ds_read_b64 v[240:241], v8 offset:64
  ds_read_b64 v[242:243], v8 offset:72
  ds_read_b64 v[244:245], v8 offset:96
  ds_read_b64 v[246:247], v8 offset:104
  ds_read_b64 v[248:249], v8 offset:128
  ds_read_b64 v[250:251], v8 offset:136
  ds_read_b64 v[252:253], v8 offset:160
  ds_read_b64 v[254:255], v8 offset:168
  s_call_b64 s[24:25], L_stats
  s_sub_u32 s48, s38, 147840
  s_add_u32 s49, s58, 108544
  v_lshrrev_b32 v8, s43, v14
  v_bfe_i32 v200, v8, 0, 1
  v_add_u32 v204, s48, v138
  v_or_b32 v204, v204, v200
  v_or_b32 v200, v200, v138
  v_bfe_i32 v201, v8, 1, 1
  v_add_u32 v205, s48, v139
  v_or_b32 v205, v205, v201
  v_or_b32 v201, v201, v139
  v_bfe_i32 v202, v8, 2, 1
  v_add_u32 v206, s48, v140
  v_or_b32 v206, v206, v202
  v_or_b32 v202, v202, v140
  v_bfe_i32 v203, v8, 3, 1
  v_add_u32 v207, s48, v141
  v_or_b32 v207, v207, v203
  v_or_b32 v203, v203, v141
  s_add_u32 m0, s49, 0
  s_nop 0
  buffer_load_dwordx4 v204, s[4:7], 0 offen lds
  s_add_u32 m0, s49, 4096
  s_nop 0
  buffer_load_dwordx4 v205, s[4:7], 0 offen lds
  s_add_u32 m0, s49, 8192
  s_nop 0
  buffer_load_dwordx4 v206, s[4:7], 0 offen lds
  s_add_u32 m0, s49, 12288
  s_nop 0
  buffer_load_dwordx4 v207, s[4:7], 0 offen lds
  s_add_u32 m0, s49, 16240
  s_add_u32 s31, s48, 516096
  buffer_load_dwordx4 v200, s[4:7], s31 offen lds
  s_add_u32 m0, s49, 20336
  s_add_u32 s31, s48, 516096
  buffer_load_dwordx4 v201, s[4:7], s31 offen lds
  s_add_u32 m0, s49, 24432
  s_add_u32 s31, s48, 516096
  buffer_load_dwordx4 v202, s[4:7], s31 offen lds
  s_cmp_ge_u32 s19, 2
  s_cbranch_scc1 L_sk_1
  s_add_u32 m0, s49, 28528
  s_add_u32 s31, s48, 516096
  buffer_load_dwordx4 v203, s[4:7], s31 offen lds
L_sk_1:
  s_cmp_ge_u32 s19, 2
  s_cbranch_scc1 L_wv_2
  s_waitcnt vmcnt(8)
  s_branch L_wv_3
L_wv_2:
  s_waitcnt vmcnt(7)
L_wv_3:
  s_barrier
  s_setprio 2
  ds_read_b128 v[40:43], v143 offset:0
  ds_read_b128 v[44:47], v143 offset:1024
  ds_read_b128 v[48:51], v143 offset:2048
  ds_read_b128 v[52:55], v143 offset:3072
  s_setprio 0
  v_add_u32 v5, 22528, v10
  s_call_b64 s[24:25], L_norm
  s_mul_i32 s30, s18, 0
  s_add_u32 s30, s30, s16
  s_add_u32 m0, s59, 0
  s_nop 0
  buffer_load_dwordx4 v11, s[12:15], s30 offen lds
  s_add_u32 m0, s59, 1024
  s_add_u32 s30, s30, s17
  buffer_load_dwordx4 v11, s[12:15], s30 offen lds
  s_add_u32 m0, s59, 2048
  s_add_u32 s30, s30, s17
  buffer_load_dwordx4 v11, s[12:15], s30 offen lds
  v_mfma_f32_32x32x8_bf16 v[144:159], v[64:65], v[64:65], 0
  v_mfma_f32_32x32x8_bf16 v[160:175], v[64:65], v[64:65], 0
  v_bfe_u32 v6, v0, 1, 3
  v_mul_u32_u24 v6, 2320, v6
  v_sub_u32 v142, v9, v6
  v_add_u32 v142, 108544, v142
  s_waitcnt vmcnt(3)
  s_barrier
  s_setprio 1
  ds_read_b64 v[40:41], v142 offset:0
  ds_read_b64 v[42:43], v142 offset:192
  ds_read_b64 v[44:45], v142 offset:776
  ds_read_b64 v[46:47], v142 offset:968
  ds_read_b64 v[48:49], v142 offset:4640
  ds_read_b64 v[50:51], v142 offset:4832
  ds_read_b64 v[52:53], v142 offset:5416
  ds_read_b64 v[54:55], v142 offset:5608
  ds_read_b64 v[56:57], v142 offset:9280
  ds_read_b64 v[58:59], v142 offset:9472
  ds_read_b64 v[60:61], v142 offset:10056
  ds_read_b64 v[62:63], v142 offset:10248
  ds_read_b64 v[168:169], v142 offset:8
  ds_read_b64 v[170:171], v142 offset:200
  s_waitcnt lgkmcnt(10)
  v_smfmac_f32_16x16x64_bf16 v[144:147], v[66:69], v[40:47], v13
  ds_read_b64 v[172:173], v142 offset:784
  ds_read_b64 v[174:175], v142 offset:976
  ds_read_b64 v[176:177], v142 offset:4648
  ds_read_b64 v[178:179], v142 offset:4840
  s_waitcnt lgkmcnt(10)
  v_smfmac_f32_16x16x64_bf16 v[144:147], v[70:73], v[48:55], v13
  ds_read_b64 v[180:181], v142 offset:5424
  ds_read_b64 v[182:183], v142 offset:5616
  ds_read_b64 v[184:185], v142 offset:9288
  ds_read_b64 v[186:187], v142 offset:9480
  s_waitcnt lgkmcnt(10)
  v_smfmac_f32_16x16x64_bf16 v[144:147], v[74:77], v[56:63], v13
  ds_read_b64 v[188:189], v142 offset:10064
  ds_read_b64 v[190:191], v142 offset:10256
  ds_read_b64 v[40:41], v142 offset:16
  ds_read_b64 v[42:43], v142 offset:208
  s_waitcnt lgkmcnt(10)
  v_smfmac_f32_16x16x64_bf16 v[148:151], v[78:81], v[168:175], v13
  ds_read_b64 v[44:45], v142 offset:792
  ds_read_b64 v[46:47], v142 offset:984
  ds_read_b64 v[48:49], v142 offset:4656
  ds_read_b64 v[50:51], v142 offset:4848
  s_waitcnt lgkmcnt(10)
  v_smfmac_f32_16x16x64_bf16 v[148:151], v[82:85], v[176:183], v13
  ds_read_b64 v[52:53], v142 offset:5432
  ds_read_b64 v[54:55], v142 offset:5624
  ds_read_b64 v[56:57], v142 offset:9296
  ds_read_b64 v[58:59], v142 offset:9488
  s_waitcnt lgkmcnt(10)
  v_smfmac_f32_16x16x64_bf16 v[148:151], v[86:89], v[184:191], v13
  ds_read_b64 v[60:61], v142 offset:10072
  ds_read_b64 v[62:63], v142 offset:10264
  ds_read_b64 v[168:169], v142 offset:24
  ds_read_b64 v[170:171], v142 offset:216
  s_waitcnt lgkmcnt(10)
  v_smfmac_f32_16x16x64_bf16 v[152:155], v[90:93], v[40:47], v13
  ds_read_b64 v[172:173], v142 offset:800
  ds_read_b64 v[174:175], v142 offset:992
  ds_read_b64 v[176:177], v142 offset:4664
  ds_read_b64 v[178:179], v142 offset:4856
  s_waitcnt lgkmcnt(10)
  v_smfmac_f32_16x16x64_bf16 v[152:155], v[94:97], v[48:55], v13
  ds_read_b64 v[180:181], v142 offset:5440
  ds_read_b64 v[182:183], v142 offset:5632
  ds_read_b64 v[184:185], v142 offset:9304
  ds_read_b64 v[186:187], v142 offset:9496
  s_waitcnt lgkmcnt(10)
  v_smfmac_f32_16x16x64_bf16 v[152:155], v[98:101], v[56:63], v13
  ds_read_b64 v[188:189], v142 offset:10080
  ds_read_b64 v[190:191], v142 offset:10272
  ds_read_b64 v[40:41], v142 offset:32
  ds_read_b64 v[42:43], v142 offset:224
  s_waitcnt lgkmcnt(10)
  v_smfmac_f32_16x16x64_bf16 v[156:159], v[102:105], v[168:175], v13
  ds_read_b64 v[44:45], v142 offset:808
  ds_read_b64 v[46:47], v142 offset:1000
  ds_read_b64 v[48:49], v142 offset:4672
  ds_read_b64 v[50:51], v142 offset:4864
  s_waitcnt lgkmcnt(10)
  v_smfmac_f32_16x16x64_bf16 v[156:159], v[106:109], v[176:183], v13
  ds_read_b64 v[52:53], v142 offset:5448
  ds_read_b64 v[54:55], v142 offset:5640
  ds_read_b64 v[56:57], v142 offset:9312
  ds_read_b64 v[58:59], v142 offset:9504
  s_waitcnt lgkmcnt(10)
  v_smfmac_f32_16x16x64_bf16 v[156:159], v[110:113], v[184:191], v13
  ds_read_b64 v[60:61], v142 offset:10088
  ds_read_b64 v[62:63], v142 offset:10280
  ds_read_b64 v[168:169], v142 offset:40
  ds_read_b64 v[170:171], v142 offset:232
  s_waitcnt lgkmcnt(10)
  v_smfmac_f32_16x16x64_bf16 v[160:163], v[114:117], v[40:47], v13
  ds_read_b64 v[172:173], v142 offset:816
  ds_read_b64 v[174:175], v142 offset:1008
  ds_read_b64 v[176:177], v142 offset:4680
  ds_read_b64 v[178:179], v142 offset:4872
  s_waitcnt lgkmcnt(10)
  v_smfmac_f32_16x16x64_bf16 v[160:163], v[118:121], v[48:55], v13
  ds_read_b64 v[180:181], v142 offset:5456
  ds_read_b64 v[182:183], v142 offset:5648
  ds_read_b64 v[184:185], v142 offset:9320
  ds_read_b64 v[186:187], v142 offset:9512
  s_waitcnt lgkmcnt(10)
  v_smfmac_f32_16x16x64_bf16 v[160:163], v[122:125], v[56:63], v13
  ds_read_b64 v[188:189], v142 offset:10096
  ds_read_b64 v[190:191], v142 offset:10288
  s_waitcnt lgkmcnt(8)
  v_smfmac_f32_16x16x64_bf16 v[164:167], v[126:129], v[168:175], v13
  s_waitcnt lgkmcnt(4)
  v_smfmac_f32_16x16x64_bf16 v[164:167], v[130:133], v[176:183], v13
  s_waitcnt lgkmcnt(0)
  v_smfmac_f32_16x16x64_bf16 v[164:167], v[134:137], v[184:191], v13
  v_add_u32 v8, 22528, v12
  ds_read_b128 v[40:43], v8 offset:0
  ds_read_b128 v[44:47], v8 offset:1024
  ds_read_b128 v[48:51], v8 offset:2048
  ds_read_b128 v[52:55], v8 offset:3072
  ds_read_b128 v[56:59], v8 offset:4096
  ds_read_b128 v[60:63], v8 offset:5120
  v_add_u32 v5, s58, v143
  v_pk_add_f32 v[192:193], v[144:145], v[146:147]
  v_pk_mul_f32 v[194:195], v[144:145], v[144:145]
  v_pk_fma_f32 v[194:195], v[146:147], v[146:147], v[194:195]
  v_pk_add_f32 v[192:193], v[192:193], v[148:149]
  v_pk_fma_f32 v[194:195], v[148:149], v[148:149], v[194:195]
  v_pk_add_f32 v[192:193], v[192:193], v[150:151]
  v_pk_fma_f32 v[194:195], v[150:151], v[150:151], v[194:195]
  v_pk_add_f32 v[192:193], v[192:193], v[152:153]
  v_pk_fma_f32 v[194:195], v[152:153], v[152:153], v[194:195]
  v_pk_add_f32 v[192:193], v[192:193], v[154:155]
  v_pk_fma_f32 v[194:195], v[154:155], v[154:155], v[194:195]
  v_pk_add_f32 v[192:193], v[192:193], v[156:157]
  v_pk_fma_f32 v[194:195], v[156:157], v[156:157], v[194:195]
  v_pk_add_f32 v[192:193], v[192:193], v[158:159]
  v_pk_fma_f32 v[194:195], v[158:159], v[158:159], v[194:195]
  v_pk_add_f32 v[192:193], v[192:193], v[160:161]
  v_pk_fma_f32 v[194:195], v[160:161], v[160:161], v[194:195]
  v_pk_add_f32 v[192:193], v[192:193], v[162:163]
  v_pk_fma_f32 v[194:195], v[162:163], v[162:163], v[194:195]
  v_pk_add_f32 v[192:193], v[192:193], v[164:165]
  v_pk_fma_f32 v[194:195], v[164:165], v[164:165], v[194:195]
  v_pk_add_f32 v[192:193], v[192:193], v[166:167]
  v_pk_fma_f32 v[194:195], v[166:167], v[166:167], v[194:195]
  v_add_f32 v192, v192, v193
  v_add_f32 v193, v194, v195
  ds_write_b128 v5, v[192:195]
  s_setprio 0
  s_waitcnt lgkmcnt(0)
  s_call_b64 s[24:25], L_setup3
  s_waitcnt vmcnt(0)
  s_barrier
  ds_read_b128 v[168:171], v143 offset:0
  ds_read_b128 v[172:175], v143 offset:1024
  ds_read_b128 v[176:179], v143 offset:2048
  ds_read_b128 v[180:183], v143 offset:3072
  v_add_u32 v5, 151552, v10
  s_waitcnt lgkmcnt(0)
  v_add_f32 v168, v168, v172
  v_add_f32 v169, v169, v173
  v_add_f32 v176, v176, v180
  v_add_f32 v177, v177, v181
  v_add_f32 v168, v168, v176
  v_add_f32 v169, v169, v177
  v_mul_f32 v168, 0x3c2aaaab, v168
  v_mul_f32 v169, 0x3c2aaaab, v169
  v_fma_f32 v169, -v168, v168, v169
  v_max_f32 v169, 0, v169
  v_add_f32 v169, 0x3727c5ac, v169
  v_rsq_f32 v169, v169
  s_nop 0
  v_mul_f32 v169, 0x3eeff558, v169
  v_mul_f32 v168, v168, v169
  v_fma_f32 v144, v144, v169, -v168
  v_fma_f32 v145, v145, v169, -v168
  v_fma_f32 v146, v146, v169, -v168
  v_fma_f32 v147, v147, v169, -v168
  v_fma_f32 v148, v148, v169, -v168
  v_fma_f32 v149, v149, v169, -v168
  v_fma_f32 v150, v150, v169, -v168
  v_fma_f32 v151, v151, v169, -v168
  v_cvt_pk_bf16_f32 v144, v144, v145
  v_cvt_pk_bf16_f32 v145, v146, v147
  v_cvt_pk_bf16_f32 v146, v148, v149
  v_cvt_pk_bf16_f32 v147, v150, v151
  v_fma_f32 v152, v152, v169, -v168
  v_fma_f32 v153, v153, v169, -v168
  v_fma_f32 v154, v154, v169, -v168
  v_fma_f32 v155, v155, v169, -v168
  v_fma_f32 v156, v156, v169, -v168
  v_fma_f32 v157, v157, v169, -v168
  v_fma_f32 v158, v158, v169, -v168
  v_fma_f32 v159, v159, v169, -v168
  v_cvt_pk_bf16_f32 v148, v152, v153
  v_cvt_pk_bf16_f32 v149, v154, v155
  v_cvt_pk_bf16_f32 v150, v156, v157
  v_cvt_pk_bf16_f32 v151, v158, v159
  v_fma_f32 v160, v160, v169, -v168
  v_fma_f32 v161, v161, v169, -v168
  v_fma_f32 v162, v162, v169, -v168
  v_fma_f32 v163, v163, v169, -v168
  v_fma_f32 v164, v164, v169, -v168
  v_fma_f32 v165, v165, v169, -v168
  v_fma_f32 v166, v166, v169, -v168
  v_fma_f32 v167, v167, v169, -v168
  v_cvt_pk_bf16_f32 v152, v160, v161
  v_cvt_pk_bf16_f32 v153, v162, v163
  v_cvt_pk_bf16_f32 v154, v164, v165
  v_cvt_pk_bf16_f32 v155, v166, v167
  ds_write_b128 v5, v[144:147] offset:0
  ds_write_b128 v5, v[148:151] offset:512
  ds_write_b128 v5, v[152:155] offset:1024
  s_mul_i32 s100, s3, 0
  s_add_u32 s100, s100, 1
  s_mul_i32 s101, s100, 12288
  s_add_u32 s101, s101, s59
  s_mul_i32 s100, s100, s18
  s_mov_b32 m0, s101
  s_add_u32 s100, s100, s16
  buffer_load_dwordx4 v11, s[12:15], s100 offen lds
  s_add_u32 m0, s101, 1024
  s_add_u32 s100, s100, s17
  buffer_load_dwordx4 v11, s[12:15], s100 offen lds
  s_add_u32 m0, s101, 2048
  s_add_u32 s100, s100, s17
  buffer_load_dwordx4 v11, s[12:15], s100 offen lds
  s_mul_i32 s100, s3, 0
  s_add_u32 s100, s100, 2
  s_mul_i32 s101, s100, 12288
  s_add_u32 s101, s101, s59
  s_mul_i32 s100, s100, s18
  s_mov_b32 m0, s101
  s_add_u32 s100, s100, s16
  buffer_load_dwordx4 v11, s[12:15], s100 offen lds
  s_add_u32 m0, s101, 1024
  s_add_u32 s100, s100, s17
  buffer_load_dwordx4 v11, s[12:15], s100 offen lds
  s_add_u32 m0, s101, 2048
  s_add_u32 s100, s100, s17
  buffer_load_dwordx4 v11, s[12:15], s100 offen lds
  s_mul_i32 s100, s3, 0
  s_add_u32 s100, s100, 3
  s_mul_i32 s101, s100, 12288
  s_add_u32 s101, s101, s59
  s_mul_i32 s100, s100, s18
  s_mov_b32 m0, s101
  s_add_u32 s100, s100, s16
  buffer_load_dwordx4 v11, s[12:15], s100 offen lds
  s_add_u32 m0, s101, 1024
  s_add_u32 s100, s100, s17
  buffer_load_dwordx4 v11, s[12:15], s100 offen lds
  s_add_u32 m0, s101, 2048
  s_add_u32 s100, s100, s17
  buffer_load_dwordx4 v11, s[12:15], s100 offen lds
  s_waitcnt lgkmcnt(0)
  s_branch L_ffn
L_setup:
  ds_read_b64_tr_b16 v[66:67], v192 offset:0
  ds_read_b64_tr_b16 v[68:69], v192 offset:960
  ds_read_b64_tr_b16 v[70:71], v192 offset:1920
  ds_read_b64_tr_b16 v[72:73], v192 offset:2880
  ds_read_b64_tr_b16 v[74:75], v192 offset:3840
  ds_read_b64_tr_b16 v[78:79], v192 offset:8
  ds_read_b64_tr_b16 v[80:81], v192 offset:968
  ds_read_b64_tr_b16 v[82:83], v192 offset:1928
  ds_read_b64_tr_b16 v[84:85], v192 offset:2888
  ds_read_b64_tr_b16 v[86:87], v192 offset:3848
  ds_read_b64_tr_b16 v[90:91], v192 offset:16
  ds_read_b64_tr_b16 v[92:93], v192 offset:976
  ds_read_b64_tr_b16 v[94:95], v192 offset:1936
  ds_read_b64_tr_b16 v[96:97], v192 offset:2896
  ds_read_b64_tr_b16 v[98:99], v192 offset:3856
  ds_read_b64_tr_b16 v[102:103], v192 offset:24
  ds_read_b64_tr_b16 v[104:105], v192 offset:984
  ds_read_b64_tr_b16 v[106:107], v192 offset:1944
  ds_read_b64_tr_b16 v[108:109], v192 offset:2904
  ds_read_b64_tr_b16 v[110:111], v192 offset:3864
  ds_read_b64_tr_b16 v[114:115], v192 offset:32
  ds_read_b64_tr_b16 v[116:117], v192 offset:992
  ds_read_b64_tr_b16 v[118:119], v192 offset:1952
  ds_read_b64_tr_b16 v[120:121], v192 offset:2912
  ds_read_b64_tr_b16 v[122:123], v192 offset:3872
  ds_read_b64_tr_b16 v[126:127], v192 offset:40
  ds_read_b64_tr_b16 v[128:129], v192 offset:1000
  ds_read_b64_tr_b16 v[130:131], v192 offset:1960
  ds_read_b64_tr_b16 v[132:133], v192 offset:2920
  ds_read_b64_tr_b16 v[134:135], v192 offset:3880
  s_setpc_b64 s[24:25]
L_setupc:
  v_and_b32 v5, 14, v0
  v_mul_u32_u24 v15, 2320, v5
  v_and_b32 v5, 1, v0
  v_mul_u32_u24 v5, 776, v5
  v_add_u32 v15, v15, v5
  v_bfe_u32 v7, v0, 4, 1
  v_mul_u32_u24 v5, 2320, v7
  v_bfe_u32 v8, v0, 5, 1
  v_mul_u32_u24 v6, 384, v8
  v_add3_u32 v9, v15, v5, v6
  s_mul_i32 s30, s19, 48
  v_add_u32 v9, s30, v9
  v_mul_u32_u24 v5, 192, v7
  v_lshl_add_u32 v3, v8, 4, v5
  s_lshr_b32 s30, s19, 1
  s_mul_i32 s31, s30, 2320
  s_and_b32 s32, s19, 1
  s_mul_i32 s33, s32, 392
  s_add_u32 s31, s31, s33
  s_add_u32 s31, s31, 5024
  v_add3_u32 v15, v15, v3, s31
  v_mul_u32_u24 v5, 6144, v8
  v_and_b32 v7, 31, v0
  v_lshl_add_u32 v5, v7, 4, v5
  s_mul_i32 s30, s19, 1536
  v_add_u32 v10, s30, v5
  s_mul_i32 s30, s19, 6144
  v_add_u32 v12, s30, v4
  v_and_b32 v7, 3, v0
  v_mul_u32_u24 v13, 0x5555, v7
  s_mov_b32 s26, 0
  s_setpc_b64 s[24:25]
L_setup2:
  s_add_u32 s30, s29, 64
  s_mul_i32 s31, s30, 171
  s_lshr_b32 s31, s31, 10
  s_mul_i32 s32, s31, 6
  s_sub_u32 s32, s30, s32
  s_add_u32 s32, s32, s3
  s_mul_i32 s36, s31, 1179648
  s_mul_i32 s33, s32, 1536
  s_add_u32 s36, s36, s33
  s_cmp_eq_u32 s32, 0
  s_cselect_b32 s41, 0, 8
  s_cmp_eq_u32 s32, 47
  s_cselect_b32 s41, 4, s41
  s_add_u32 s30, s29, 96
  s_mul_i32 s31, s30, 171
  s_lshr_b32 s31, s31, 10
  s_mul_i32 s32, s31, 6
  s_sub_u32 s32, s30, s32
  s_add_u32 s32, s32, s3
  s_mul_i32 s37, s31, 1179648
  s_mul_i32 s33, s32, 1536
  s_add_u32 s37, s37, s33
  s_cmp_eq_u32 s32, 0
  s_cselect_b32 s42, 0, 8
  s_cmp_eq_u32 s32, 47
  s_cselect_b32 s42, 4, s42
  s_lshr_b32 s30, s29, 1
  s_add_u32 s30, s30, 128
  s_mul_i32 s31, s30, 171
  s_lshr_b32 s31, s31, 10
  s_mul_i32 s32, s31, 6
  s_sub_u32 s32, s30, s32
  s_add_u32 s32, s32, s3
  s_mul_i32 s38, s31, 1179648
  s_mul_i32 s33, s32, 1536
  s_add_u32 s38, s38, s33
  s_and_b32 s33, s29, 1
  s_mul_i32 s33, s33, 589824
  s_add_u32 s38, s38, s33
  s_cmp_eq_u32 s32, 0
  s_cselect_b32 s43, 0, 8
  s_cmp_eq_u32 s32, 47
  s_cselect_b32 s43, 4, s43
  s_lshr_b32 s3, s28, 2
  s_cmp_lt_u32 s19, 2
  s_cselect_b32 s12, s96, s98
  s_cselect_b32 s13, s97, s99
  s_mov_b32 s14, 73728
  s_mov_b32 s15, 0x20000
  s_movk_i32 s17, 1024
  s_cselect_b32 s17, 12288, s17
  s_cselect_b32 s18, 64, 6144
  s_cselect_b32 s30, 768, 64
  s_and_b32 s31, s19, 1
  s_mul_i32 s16, s17, 3
  s_mul_i32 s16, s16, s31
  s_mul_i32 s59, s19, 3072
  v_bfe_u32 v5, v0, 2, 4
  v_mul_u32_u24 v5, s30, v5
  v_and_b32 v7, 3, v0
  v_lshl_add_u32 v11, v7, 4, v5
  s_setpc_b64 s[24:25]
L_setup3:
  s_mov_b32 s10, 28311552
  s_mov_b32 s11, 0x20000
  v_and_b32 v6, 14, v0
  s_mov_b32 s33, 73728
  v_mul_lo_u32 v5, v6, s33
  v_and_b32 v6, 1, v0
  v_mul_u32_u24 v6, 768, v6
  v_add3_u32 v3, v3, v5, v6
  s_lshr_b32 s30, s19, 1
  s_mul_i32 s30, s30, 73728
  s_and_b32 s32, s19, 1
  s_mul_i32 s32, s32, 384
  s_add_u32 s30, s30, s32
  s_cmp_eq_u32 s3, 0
  s_cselect_b32 s56, s34, s35
  s_cselect_b32 s57, s36, s37
  s_add_u32 s56, s56, s30
  s_add_u32 s57, s57, s30
  v_bfe_u32 v5, v0, 4, 1
  v_lshlrev_b32 v5, 5, v5
  v_and_b32 v7, 1, v0
  v_lshl_add_u32 v5, v7, 4, v5
  v_bfe_u32 v7, v0, 1, 1
  v_lshl_add_u32 v5, v7, 3, v5
  v_bfe_u32 v7, v0, 2, 2
  v_bfe_u32 v8, v0, 5, 1
  v_lshl_add_u32 v7, v8, 3, v7
  v_lshl_add_u32 v1, v7, 6, v5
  v_mul_u32_u24 v7, 192, v7
  v_add_u32 v2, v7, v5
  s_mov_b32 s44, 0x409d30fc
  s_mov_b32 s45, 0x409d30fc
  s_mov_b32 s46, 0x3eeff558
  s_mov_b32 s47, 0x3eeff558
  s_setpc_b64 s[24:25]
L_core:
  s_setprio 1
  ds_read_b64 v[40:41], v142 offset:0
  ds_read_b64 v[42:43], v142 offset:192
  ds_read_b64 v[44:45], v142 offset:776
  ds_read_b64 v[46:47], v142 offset:968
  ds_read_b64 v[48:49], v142 offset:4640
  ds_read_b64 v[50:51], v142 offset:4832
  ds_read_b64 v[52:53], v142 offset:5416
  ds_read_b64 v[54:55], v142 offset:5608
  ds_read_b64 v[56:57], v142 offset:9280
  ds_read_b64 v[58:59], v142 offset:9472
  ds_read_b64 v[60:61], v142 offset:10056
  ds_read_b64 v[62:63], v142 offset:10248
  ds_read_b64 v[232:233], v142 offset:8
  ds_read_b64 v[234:235], v142 offset:200
  s_waitcnt lgkmcnt(10)
  v_smfmac_f32_16x16x64_bf16 v[144:147], v[66:69], v[40:47], v13
  ds_read_b64 v[236:237], v142 offset:784
  ds_read_b64 v[238:239], v142 offset:976
  v_smfmac_f32_16x16x64_bf16 v[168:171], v[64:67], v[40:47], v13
  ds_read_b64 v[240:241], v142 offset:4648
  ds_read_b64 v[242:243], v142 offset:4840
  s_cmp_eq_u32 s26, 0
  s_cbranch_scc1 L_gam_4
  s_barrier
L_gam_4:
  s_waitcnt lgkmcnt(10)
  v_smfmac_f32_16x16x64_bf16 v[144:147], v[70:73], v[48:55], v13
  ds_read_b64 v[244:245], v142 offset:5424
  ds_read_b64 v[246:247], v142 offset:5616
  v_smfmac_f32_16x16x64_bf16 v[168:171], v[68:71], v[48:55], v13
  ds_read_b64 v[248:249], v142 offset:9288
  ds_read_b64 v[250:251], v142 offset:9480
  s_waitcnt lgkmcnt(10)
  v_smfmac_f32_16x16x64_bf16 v[144:147], v[74:77], v[56:63], v13
  ds_read_b64 v[252:253], v142 offset:10064
  ds_read_b64 v[254:255], v142 offset:10256
  v_smfmac_f32_16x16x64_bf16 v[168:171], v[72:75], v[56:63], v13
  ds_read_b64 v[40:41], v142 offset:16
  ds_read_b64 v[42:43], v142 offset:208
  s_waitcnt lgkmcnt(10)
  v_smfmac_f32_16x16x64_bf16 v[148:151], v[78:81], v[232:239], v13
  ds_read_b64 v[44:45], v142 offset:792
  ds_read_b64 v[46:47], v142 offset:984
  v_smfmac_f32_16x16x64_bf16 v[172:175], v[76:79], v[232:239], v13
  ds_read_b64 v[48:49], v142 offset:4656
  ds_read_b64 v[50:51], v142 offset:4848
  s_waitcnt lgkmcnt(10)
  v_smfmac_f32_16x16x64_bf16 v[148:151], v[82:85], v[240:247], v13
  ds_read_b64 v[52:53], v142 offset:5432
  ds_read_b64 v[54:55], v142 offset:5624
  v_smfmac_f32_16x16x64_bf16 v[172:175], v[80:83], v[240:247], v13
  ds_read_b64 v[56:57], v142 offset:9296
  ds_read_b64 v[58:59], v142 offset:9488
  s_waitcnt lgkmcnt(10)
  v_smfmac_f32_16x16x64_bf16 v[148:151], v[86:89], v[248:255], v13
  ds_read_b64 v[60:61], v142 offset:10072
  ds_read_b64 v[62:63], v142 offset:10264
  v_smfmac_f32_16x16x64_bf16 v[172:175], v[84:87], v[248:255], v13
  ds_read_b64 v[232:233], v142 offset:24
  ds_read_b64 v[234:235], v142 offset:216
  s_waitcnt lgkmcnt(10)
  v_smfmac_f32_16x16x64_bf16 v[152:155], v[90:93], v[40:47], v13
  ds_read_b64 v[236:237], v142 offset:800
  ds_read_b64 v[238:239], v142 offset:992
  v_smfmac_f32_16x16x64_bf16 v[176:179], v[88:91], v[40:47], v13
  ds_read_b64 v[240:241], v142 offset:4664
  ds_read_b64 v[242:243], v142 offset:4856
  s_waitcnt lgkmcnt(10)
  v_smfmac_f32_16x16x64_bf16 v[152:155], v[94:97], v[48:55], v13
  ds_read_b64 v[244:245], v142 offset:5440
  ds_read_b64 v[246:247], v142 offset:5632
  v_smfmac_f32_16x16x64_bf16 v[176:179], v[92:95], v[48:55], v13
  ds_read_b64 v[248:249], v142 offset:9304
  ds_read_b64 v[250:251], v142 offset:9496
  s_waitcnt lgkmcnt(10)
  v_smfmac_f32_16x16x64_bf16 v[152:155], v[98:101], v[56:63], v13
  ds_read_b64 v[252:253], v142 offset:10080
  ds_read_b64 v[254:255], v142 offset:10272
  v_smfmac_f32_16x16x64_bf16 v[176:179], v[96:99], v[56:63], v13
  ds_read_b64 v[40:41], v142 offset:32
  ds_read_b64 v[42:43], v142 offset:224
  s_waitcnt lgkmcnt(10)
  v_smfmac_f32_16x16x64_bf16 v[156:159], v[102:105], v[232:239], v13
  ds_read_b64 v[44:45], v142 offset:808
  ds_read_b64 v[46:47], v142 offset:1000
  v_smfmac_f32_16x16x64_bf16 v[180:183], v[100:103], v[232:239], v13
  ds_read_b64 v[48:49], v142 offset:4672
  ds_read_b64 v[50:51], v142 offset:4864
  s_waitcnt lgkmcnt(10)
  v_smfmac_f32_16x16x64_bf16 v[156:159], v[106:109], v[240:247], v13
  ds_read_b64 v[52:53], v142 offset:5448
  ds_read_b64 v[54:55], v142 offset:5640
  v_smfmac_f32_16x16x64_bf16 v[180:183], v[104:107], v[240:247], v13
  ds_read_b64 v[56:57], v142 offset:9312
  ds_read_b64 v[58:59], v142 offset:9504
  s_waitcnt lgkmcnt(10)
  v_smfmac_f32_16x16x64_bf16 v[156:159], v[110:113], v[248:255], v13
  ds_read_b64 v[60:61], v142 offset:10088
  ds_read_b64 v[62:63], v142 offset:10280
  v_smfmac_f32_16x16x64_bf16 v[180:183], v[108:111], v[248:255], v13
  ds_read_b64 v[232:233], v142 offset:40
  ds_read_b64 v[234:235], v142 offset:232
  s_waitcnt lgkmcnt(10)
  v_smfmac_f32_16x16x64_bf16 v[160:163], v[114:117], v[40:47], v13
  ds_read_b64 v[236:237], v142 offset:816
  ds_read_b64 v[238:239], v142 offset:1008
  v_smfmac_f32_16x16x64_bf16 v[184:187], v[112:115], v[40:47], v13
  ds_read_b64 v[240:241], v142 offset:4680
  ds_read_b64 v[242:243], v142 offset:4872
  s_waitcnt lgkmcnt(10)
  v_smfmac_f32_16x16x64_bf16 v[160:163], v[118:121], v[48:55], v13
  ds_read_b64 v[244:245], v142 offset:5456
  ds_read_b64 v[246:247], v142 offset:5648
  v_smfmac_f32_16x16x64_bf16 v[184:187], v[116:119], v[48:55], v13
  ds_read_b64 v[248:249], v142 offset:9320
  ds_read_b64 v[250:251], v142 offset:9512
  s_waitcnt lgkmcnt(10)
  v_smfmac_f32_16x16x64_bf16 v[160:163], v[122:125], v[56:63], v13
  ds_read_b64 v[252:253], v142 offset:10096
  ds_read_b64 v[254:255], v142 offset:10288
  v_smfmac_f32_16x16x64_bf16 v[184:187], v[120:123], v[56:63], v13
  s_waitcnt lgkmcnt(8)
  v_smfmac_f32_16x16x64_bf16 v[164:167], v[126:129], v[232:239], v13
  v_smfmac_f32_16x16x64_bf16 v[188:191], v[124:127], v[232:239], v13
  s_waitcnt lgkmcnt(4)
  v_smfmac_f32_16x16x64_bf16 v[164:167], v[130:133], v[240:247], v13
  v_smfmac_f32_16x16x64_bf16 v[188:191], v[128:131], v[240:247], v13
  s_waitcnt lgkmcnt(0)
  v_smfmac_f32_16x16x64_bf16 v[164:167], v[134:137], v[248:255], v13
  v_smfmac_f32_16x16x64_bf16 v[188:191], v[132:135], v[248:255], v13
  s_setpc_b64 s[24:25]
L_stats:
  v_add_u32 v5, s58, v143
  v_pk_add_f32 v[192:193], v[144:145], v[146:147]
  v_pk_mul_f32 v[194:195], v[144:145], v[144:145]
  v_pk_fma_f32 v[194:195], v[146:147], v[146:147], v[194:195]
  v_pk_add_f32 v[192:193], v[192:193], v[148:149]
  v_pk_fma_f32 v[194:195], v[148:149], v[148:149], v[194:195]
  v_pk_add_f32 v[192:193], v[192:193], v[150:151]
  v_pk_fma_f32 v[194:195], v[150:151], v[150:151], v[194:195]
  v_pk_add_f32 v[192:193], v[192:193], v[152:153]
  v_pk_fma_f32 v[194:195], v[152:153], v[152:153], v[194:195]
  v_pk_add_f32 v[192:193], v[192:193], v[154:155]
  v_pk_fma_f32 v[194:195], v[154:155], v[154:155], v[194:195]
  v_pk_add_f32 v[192:193], v[192:193], v[156:157]
  v_pk_fma_f32 v[194:195], v[156:157], v[156:157], v[194:195]
  v_pk_add_f32 v[192:193], v[192:193], v[158:159]
  v_pk_fma_f32 v[194:195], v[158:159], v[158:159], v[194:195]
  v_pk_add_f32 v[192:193], v[192:193], v[160:161]
  v_pk_fma_f32 v[194:195], v[160:161], v[160:161], v[194:195]
  v_pk_add_f32 v[192:193], v[192:193], v[162:163]
  v_pk_fma_f32 v[194:195], v[162:163], v[162:163], v[194:195]
  v_pk_add_f32 v[192:193], v[192:193], v[164:165]
  v_pk_fma_f32 v[194:195], v[164:165], v[164:165], v[194:195]
  v_pk_add_f32 v[192:193], v[192:193], v[166:167]
  v_pk_fma_f32 v[194:195], v[166:167], v[166:167], v[194:195]
  v_pk_add_f32 v[196:197], v[168:169], v[170:171]
  v_pk_mul_f32 v[198:199], v[168:169], v[168:169]
  v_pk_fma_f32 v[198:199], v[170:171], v[170:171], v[198:199]
  v_pk_add_f32 v[196:197], v[196:197], v[172:173]
  v_pk_fma_f32 v[198:199], v[172:173], v[172:173], v[198:199]
  v_pk_add_f32 v[196:197], v[196:197], v[174:175]
  v_pk_fma_f32 v[198:199], v[174:175], v[174:175], v[198:199]
  v_pk_add_f32 v[196:197], v[196:197], v[176:177]
  v_pk_fma_f32 v[198:199], v[176:177], v[176:177], v[198:199]
  v_pk_add_f32 v[196:197], v[196:197], v[178:179]
  v_pk_fma_f32 v[198:199], v[178:179], v[178:179], v[198:199]
  v_pk_add_f32 v[196:197], v[196:197], v[180:181]
  v_pk_fma_f32 v[198:199], v[180:181], v[180:181], v[198:199]
  v_pk_add_f32 v[196:197], v[196:197], v[182:183]
  v_pk_fma_f32 v[198:199], v[182:183], v[182:183], v[198:199]
  v_pk_add_f32 v[196:197], v[196:197], v[184:185]
  v_pk_fma_f32 v[198:199], v[184:185], v[184:185], v[198:199]
  v_pk_add_f32 v[196:197], v[196:197], v[186:187]
  v_pk_fma_f32 v[198:199], v[186:187], v[186:187], v[198:199]
  v_pk_add_f32 v[196:197], v[196:197], v[188:189]
  v_pk_fma_f32 v[198:199], v[188:189], v[188:189], v[198:199]
  v_pk_add_f32 v[196:197], v[196:197], v[190:191]
  v_pk_fma_f32 v[198:199], v[190:191], v[190:191], v[198:199]
  v_add_f32 v192, v192, v193
  v_add_f32 v193, v194, v195
  v_add_f32 v194, v196, v197
  v_add_f32 v195, v198, v199
  ds_write_b128 v5, v[192:195]
  s_setprio 0
  s_waitcnt lgkmcnt(0)
  s_setpc_b64 s[24:25]
L_normd:
  s_waitcnt lgkmcnt(0)
  v_add_f32 v40, v40, v44
  v_add_f32 v41, v41, v45
  v_add_f32 v42, v42, v46
  v_add_f32 v43, v43, v47
  v_add_f32 v48, v48, v52
  v_add_f32 v49, v49, v53
  v_add_f32 v50, v50, v54
  v_add_f32 v51, v51, v55
  v_add_f32 v40, v40, v48
  v_add_f32 v41, v41, v49
  v_add_f32 v42, v42, v50
  v_add_f32 v43, v43, v51
  v_mul_f32 v40, 0x3c2aaaab, v40
  v_mul_f32 v42, 0x3c2aaaab, v42
  v_mul_f32 v41, 0x3c2aaaab, v41
  v_mul_f32 v43, 0x3c2aaaab, v43
  v_fma_f32 v41, -v40, v40, v41
  v_fma_f32 v43, -v42, v42, v43
  v_max_f32 v41, 0, v41
  v_max_f32 v43, 0, v43
  v_add_f32 v41, 0x3727c5ac, v41
  v_add_f32 v43, 0x3727c5ac, v43
  v_rsq_f32 v41, v41
  v_rsq_f32 v43, v43
  s_nop 0
  v_mul_f32 v41, 0x3eeff558, v41
  v_mul_f32 v43, 0x3eeff558, v43
  v_mul_f32 v40, v40, v41
  v_mul_f32 v42, v42, v43
  v_fma_f32 v144, v144, v41, -v40
  v_fma_f32 v145, v145, v41, -v40
  v_fma_f32 v146, v146, v41, -v40
  v_fma_f32 v147, v147, v41, -v40
  v_fma_f32 v148, v148, v41, -v40
  v_fma_f32 v149, v149, v41, -v40
  v_fma_f32 v150, v150, v41, -v40
  v_fma_f32 v151, v151, v41, -v40
  v_cvt_pk_bf16_f32 v144, v144, v145
  v_cvt_pk_bf16_f32 v145, v146, v147
  v_cvt_pk_bf16_f32 v146, v148, v149
  v_cvt_pk_bf16_f32 v147, v150, v151
  v_fma_f32 v152, v152, v41, -v40
  v_fma_f32 v153, v153, v41, -v40
  v_fma_f32 v154, v154, v41, -v40
  v_fma_f32 v155, v155, v41, -v40
  v_fma_f32 v156, v156, v41, -v40
  v_fma_f32 v157, v157, v41, -v40
  v_fma_f32 v158, v158, v41, -v40
  v_fma_f32 v159, v159, v41, -v40
  v_cvt_pk_bf16_f32 v148, v152, v153
  v_cvt_pk_bf16_f32 v149, v154, v155
  v_cvt_pk_bf16_f32 v150, v156, v157
  v_cvt_pk_bf16_f32 v151, v158, v159
  v_fma_f32 v160, v160, v41, -v40
  v_fma_f32 v161, v161, v41, -v40
  v_fma_f32 v162, v162, v41, -v40
  v_fma_f32 v163, v163, v41, -v40
  v_fma_f32 v164, v164, v41, -v40
  v_fma_f32 v165, v165, v41, -v40
  v_fma_f32 v166, v166, v41, -v40
  v_fma_f32 v167, v167, v41, -v40
  v_cvt_pk_bf16_f32 v152, v160, v161
  v_cvt_pk_bf16_f32 v153, v162, v163
  v_cvt_pk_bf16_f32 v154, v164, v165
  v_cvt_pk_bf16_f32 v155, v166, v167
  v_fma_f32 v168, v168, v43, -v42
  v_fma_f32 v169, v169, v43, -v42
  v_fma_f32 v170, v170, v43, -v42
  v_fma_f32 v171, v171, v43, -v42
  v_fma_f32 v172, v172, v43, -v42
  v_fma_f32 v173, v173, v43, -v42
  v_fma_f32 v174, v174, v43, -v42
  v_fma_f32 v175, v175, v43, -v42
  v_cvt_pk_bf16_f32 v168, v168, v169
  v_cvt_pk_bf16_f32 v169, v170, v171
  v_cvt_pk_bf16_f32 v170, v172, v173
  v_cvt_pk_bf16_f32 v171, v174, v175
  v_fma_f32 v176, v176, v43, -v42
  v_fma_f32 v177, v177, v43, -v42
  v_fma_f32 v178, v178, v43, -v42
  v_fma_f32 v179, v179, v43, -v42
  v_fma_f32 v180, v180, v43, -v42
  v_fma_f32 v181, v181, v43, -v42
  v_fma_f32 v182, v182, v43, -v42
  v_fma_f32 v183, v183, v43, -v42
  v_cvt_pk_bf16_f32 v172, v176, v177
  v_cvt_pk_bf16_f32 v173, v178, v179
  v_cvt_pk_bf16_f32 v174, v180, v181
  v_cvt_pk_bf16_f32 v175, v182, v183
  v_fma_f32 v184, v184, v43, -v42
  v_fma_f32 v185, v185, v43, -v42
  v_fma_f32 v186, v186, v43, -v42
  v_fma_f32 v187, v187, v43, -v42
  v_fma_f32 v188, v188, v43, -v42
  v_fma_f32 v189, v189, v43, -v42
  v_fma_f32 v190, v190, v43, -v42
  v_fma_f32 v191, v191, v43, -v42
  v_cvt_pk_bf16_f32 v176, v184, v185
  v_cvt_pk_bf16_f32 v177, v186, v187
  v_cvt_pk_bf16_f32 v178, v188, v189
  v_cvt_pk_bf16_f32 v179, v190, v191
  ds_write_b128 v5, v[144:147] offset:0
  ds_write_b128 v5, v[148:151] offset:512
  ds_write_b128 v5, v[152:155] offset:1024
  ds_write_b128 v5, v[168:171] offset:12288
  ds_write_b128 v5, v[172:175] offset:12800
  ds_write_b128 v5, v[176:179] offset:13312
  s_add_u32 m0, s49, 0
  s_nop 0
  buffer_load_dwordx4 v204, s[4:7], 0 offen lds
  s_add_u32 m0, s49, 4096
  s_nop 0
  buffer_load_dwordx4 v205, s[4:7], 0 offen lds
  s_add_u32 m0, s49, 8192
  s_nop 0
  buffer_load_dwordx4 v206, s[4:7], 0 offen lds
  s_add_u32 m0, s49, 12288
  s_nop 0
  buffer_load_dwordx4 v207, s[4:7], 0 offen lds
  s_add_u32 m0, s49, 16240
  s_add_u32 s31, s48, 516096
  buffer_load_dwordx4 v200, s[4:7], s31 offen lds
  s_add_u32 m0, s49, 20336
  s_add_u32 s31, s48, 516096
  buffer_load_dwordx4 v201, s[4:7], s31 offen lds
  s_add_u32 m0, s49, 24432
  s_add_u32 s31, s48, 516096
  buffer_load_dwordx4 v202, s[4:7], s31 offen lds
  s_cmp_eq_u32 s27, 0
  s_cbranch_scc1 L_gd_5
  s_add_u32 m0, s49, 28528
  s_add_u32 s31, s48, 516096
  buffer_load_dwordx4 v203, s[4:7], s31 offen lds
L_gd_5:
  s_waitcnt lgkmcnt(0)
  s_setpc_b64 s[24:25]
L_norm:
  s_waitcnt lgkmcnt(0)
  v_add_f32 v40, v40, v44
  v_add_f32 v41, v41, v45
  v_add_f32 v42, v42, v46
  v_add_f32 v43, v43, v47
  v_add_f32 v48, v48, v52
  v_add_f32 v49, v49, v53
  v_add_f32 v50, v50, v54
  v_add_f32 v51, v51, v55
  v_add_f32 v40, v40, v48
  v_add_f32 v41, v41, v49
  v_add_f32 v42, v42, v50
  v_add_f32 v43, v43, v51
  v_mul_f32 v40, 0x3c2aaaab, v40
  v_mul_f32 v42, 0x3c2aaaab, v42
  v_mul_f32 v41, 0x3c2aaaab, v41
  v_mul_f32 v43, 0x3c2aaaab, v43
  v_fma_f32 v41, -v40, v40, v41
  v_fma_f32 v43, -v42, v42, v43
  v_max_f32 v41, 0, v41
  v_max_f32 v43, 0, v43
  v_add_f32 v41, 0x3727c5ac, v41
  v_add_f32 v43, 0x3727c5ac, v43
  v_rsq_f32 v41, v41
  v_rsq_f32 v43, v43
  s_nop 0
  v_mul_f32 v41, 0x3eeff558, v41
  v_mul_f32 v43, 0x3eeff558, v43
  v_mul_f32 v40, v40, v41
  v_mul_f32 v42, v42, v43
  v_fma_f32 v144, v144, v41, -v40
  v_fma_f32 v145, v145, v41, -v40
  v_fma_f32 v146, v146, v41, -v40
  v_fma_f32 v147, v147, v41, -v40
  v_fma_f32 v148, v148, v41, -v40
  v_fma_f32 v149, v149, v41, -v40
  v_fma_f32 v150, v150, v41, -v40
  v_fma_f32 v151, v151, v41, -v40
  v_cvt_pk_bf16_f32 v144, v144, v145
  v_cvt_pk_bf16_f32 v145, v146, v147
  v_cvt_pk_bf16_f32 v146, v148, v149
  v_cvt_pk_bf16_f32 v147, v150, v151
  v_fma_f32 v152, v152, v41, -v40
  v_fma_f32 v153, v153, v41, -v40
  v_fma_f32 v154, v154, v41, -v40
  v_fma_f32 v155, v155, v41, -v40
  v_fma_f32 v156, v156, v41, -v40
  v_fma_f32 v157, v157, v41, -v40
  v_fma_f32 v158, v158, v41, -v40
  v_fma_f32 v159, v159, v41, -v40
  v_cvt_pk_bf16_f32 v148, v152, v153
  v_cvt_pk_bf16_f32 v149, v154, v155
  v_cvt_pk_bf16_f32 v150, v156, v157
  v_cvt_pk_bf16_f32 v151, v158, v159
  v_fma_f32 v160, v160, v41, -v40
  v_fma_f32 v161, v161, v41, -v40
  v_fma_f32 v162, v162, v41, -v40
  v_fma_f32 v163, v163, v41, -v40
  v_fma_f32 v164, v164, v41, -v40
  v_fma_f32 v165, v165, v41, -v40
  v_fma_f32 v166, v166, v41, -v40
  v_fma_f32 v167, v167, v41, -v40
  v_cvt_pk_bf16_f32 v152, v160, v161
  v_cvt_pk_bf16_f32 v153, v162, v163
  v_cvt_pk_bf16_f32 v154, v164, v165
  v_cvt_pk_bf16_f32 v155, v166, v167
  v_fma_f32 v168, v168, v43, -v42
  v_fma_f32 v169, v169, v43, -v42
  v_fma_f32 v170, v170, v43, -v42
  v_fma_f32 v171, v171, v43, -v42
  v_fma_f32 v172, v172, v43, -v42
  v_fma_f32 v173, v173, v43, -v42
  v_fma_f32 v174, v174, v43, -v42
  v_fma_f32 v175, v175, v43, -v42
  v_cvt_pk_bf16_f32 v168, v168, v169
  v_cvt_pk_bf16_f32 v169, v170, v171
  v_cvt_pk_bf16_f32 v170, v172, v173
  v_cvt_pk_bf16_f32 v171, v174, v175
  v_fma_f32 v176, v176, v43, -v42
  v_fma_f32 v177, v177, v43, -v42
  v_fma_f32 v178, v178, v43, -v42
  v_fma_f32 v179, v179, v43, -v42
  v_fma_f32 v180, v180, v43, -v42
  v_fma_f32 v181, v181, v43, -v42
  v_fma_f32 v182, v182, v43, -v42
  v_fma_f32 v183, v183, v43, -v42
  v_cvt_pk_bf16_f32 v172, v176, v177
  v_cvt_pk_bf16_f32 v173, v178, v179
  v_cvt_pk_bf16_f32 v174, v180, v181
  v_cvt_pk_bf16_f32 v175, v182, v183
  v_fma_f32 v184, v184, v43, -v42
  v_fma_f32 v185, v185, v43, -v42
  v_fma_f32 v186, v186, v43, -v42
  v_fma_f32 v187, v187, v43, -v42
  v_fma_f32 v188, v188, v43, -v42
  v_fma_f32 v189, v189, v43, -v42
  v_fma_f32 v190, v190, v43, -v42
  v_fma_f32 v191, v191, v43, -v42
  v_cvt_pk_bf16_f32 v176, v184, v185
  v_cvt_pk_bf16_f32 v177, v186, v187
  v_cvt_pk_bf16_f32 v178, v188, v189
  v_cvt_pk_bf16_f32 v179, v190, v191
  ds_write_b128 v5, v[144:147] offset:0
  ds_write_b128 v5, v[148:151] offset:512
  ds_write_b128 v5, v[152:155] offset:1024
  ds_write_b128 v5, v[168:171] offset:12288
  ds_write_b128 v5, v[172:175] offset:12800
  ds_write_b128 v5, v[176:179] offset:13312
  s_waitcnt lgkmcnt(0)
  s_setpc_b64 s[24:25]
L_grpB:
  s_mov_b32 s30, 71408
  s_movk_i32 s31, 1338
  v_and_b32 v5, 255, v0
  v_add_u32 v5, 512, v5
  v_mul_u32_u24 v7, 7232, v5
  v_lshrrev_b32 v7, 20, v7
  v_mul_u32_u24 v8, 145, v7
  v_sub_u32 v8, v5, v8
  v_lshlrev_b32 v5, 4, v5
  v_mad_u32_u24 v140, v7, s30, v5
  v_mad_u32_u24 v7, v8, s31, s31
  v_lshrrev_b32 v7, 16, v7
  v_mad_i32_i24 v140, v7, -8, v140
  v_subrev_u32 v7, 24, v8
  v_lshrrev_b32 v7, 31, v7
  v_lshl_or_b32 v14, v7, 2, v14
  v_sub_u32 v7, 120, v8
  v_lshrrev_b32 v7, 31, v7
  v_lshl_or_b32 v14, v7, 6, v14
  v_and_b32 v5, 255, v0
  v_add_u32 v5, 768, v5
  v_mul_u32_u24 v7, 7232, v5
  v_lshrrev_b32 v7, 20, v7
  v_mul_u32_u24 v8, 145, v7
  v_sub_u32 v8, v5, v8
  v_lshlrev_b32 v5, 4, v5
  v_mad_u32_u24 v141, v7, s30, v5
  v_mad_u32_u24 v7, v8, s31, s31
  v_lshrrev_b32 v7, 16, v7
  v_mad_i32_i24 v141, v7, -8, v141
  v_subrev_u32 v7, 24, v8
  v_lshrrev_b32 v7, 31, v7
  v_lshl_or_b32 v14, v7, 3, v14
  v_sub_u32 v7, 120, v8
  v_lshrrev_b32 v7, 31, v7
  v_lshl_or_b32 v14, v7, 7, v14
  s_sub_u32 s48, s34, 147840
  s_add_u32 s49, s58, 47104
  v_lshrrev_b32 v8, s39, v14
  v_bfe_i32 v202, v8, 2, 1
  v_add_u32 v206, s48, v140
  v_or_b32 v206, v206, v202
  v_or_b32 v202, v202, v140
  v_bfe_i32 v203, v8, 3, 1
  v_add_u32 v207, s48, v141
  v_or_b32 v207, v207, v203
  v_or_b32 v203, v203, v141
  s_waitcnt lgkmcnt(0)
  s_add_u32 m0, s49, 8192
  s_nop 0
  buffer_load_dwordx4 v206, s[4:7], 0 offen lds
  s_add_u32 m0, s49, 12288
  s_nop 0
  buffer_load_dwordx4 v207, s[4:7], 0 offen lds
  s_add_u32 m0, s49, 24432
  s_add_u32 s31, s48, 516096
  buffer_load_dwordx4 v202, s[4:7], s31 offen lds
  s_add_u32 m0, s49, 28528
  s_add_u32 s31, s48, 516096
  buffer_load_dwordx4 v203, s[4:7], s31 offen lds
  s_add_u32 m0, s49, 40672
  s_add_u32 s31, s48, 1032192
  buffer_load_dwordx4 v202, s[4:7], s31 offen lds
  s_cmp_ge_u32 s19, 2
  s_cbranch_scc1 L_sk_6
  s_add_u32 m0, s49, 44768
  s_add_u32 s31, s48, 1032192
  buffer_load_dwordx4 v203, s[4:7], s31 offen lds
L_sk_6:
  v_pk_mov_b32 v[64:65], 0, 0
  v_pk_mov_b32 v[76:77], 0, 0
  v_pk_mov_b32 v[88:89], 0, 0
  v_pk_mov_b32 v[100:101], 0, 0
  v_pk_mov_b32 v[112:113], 0, 0
  v_pk_mov_b32 v[124:125], 0, 0
  v_pk_mov_b32 v[136:137], 0, 0
  v_bfe_u32 v5, v0, 3, 3
  v_and_b32 v7, 3, v0
  v_sub_u32 v5, v5, v7
  v_cmp_gt_u32 s[32:33], 5, v5
  v_mul_u32_u24 v5, 192, v5
  v_bfe_u32 v7, v0, 2, 1
  s_movk_i32 s30, 5120
  v_mad_u32_u24 v5, v7, s30, v5
  v_mov_b32 v7, s30
  v_cndmask_b32 v5, v7, v5, s[32:33]
  s_mul_i32 s30, s19, 48
  s_add_u32 s30, s30, 106496
  v_add_u32 v192, s30, v5
  v_mfma_f32_32x32x8_bf16 v[144:159], v[64:65], v[64:65], 0
  v_mfma_f32_32x32x8_bf16 v[160:175], v[64:65], v[64:65], 0
  v_mfma_f32_32x32x8_bf16 v[176:191], v[64:65], v[64:65], 0
  v_pk_mov_b32 v[66:67], 0, 0
  s_cmp_ge_u32 s19, 2
  s_cbranch_scc1 L_zr_7
  s_mul_i32 s30, s19, 3840
  s_add_u32 s30, s30, 111616
  v_add_u32 v5, s30, v4
  ds_write_b128 v5, v[64:67]
L_zr_7:
  v_add_u32 v143, 104448, v4
  s_add_u32 s30, s29, 32
  s_mul_i32 s31, s30, 171
  s_lshr_b32 s31, s31, 10
  s_mul_i32 s32, s31, 6
  s_sub_u32 s32, s30, s32
  s_add_u32 s32, s32, s3
  s_mul_i32 s35, s31, 1179648
  s_mul_i32 s33, s32, 1536
  s_add_u32 s35, s35, s33
  s_cmp_eq_u32 s32, 0
  s_cselect_b32 s40, 0, 8
  s_cmp_eq_u32 s32, 47
  s_cselect_b32 s40, 4, s40
  s_mov_b32 s30, 71408
  s_movk_i32 s31, 1338
  v_and_b32 v5, 255, v0
  v_mul_u32_u24 v7, 7232, v5
  v_lshrrev_b32 v7, 20, v7
  v_mul_u32_u24 v8, 145, v7
  v_sub_u32 v8, v5, v8
  v_lshlrev_b32 v5, 4, v5
  v_mad_u32_u24 v138, v7, s30, v5
  v_mad_u32_u24 v7, v8, s31, s31
  v_lshrrev_b32 v7, 16, v7
  v_mad_i32_i24 v138, v7, -8, v138
  v_subrev_u32 v7, 24, v8
  v_lshrrev_b32 v7, 31, v7
  v_lshl_or_b32 v14, v7, 0, v14
  v_sub_u32 v7, 120, v8
  v_lshrrev_b32 v7, 31, v7
  v_lshl_or_b32 v14, v7, 4, v14
  v_and_b32 v5, 255, v0
  v_add_u32 v5, 256, v5
  v_mul_u32_u24 v7, 7232, v5
  v_lshrrev_b32 v7, 20, v7
  v_mul_u32_u24 v8, 145, v7
  v_sub_u32 v8, v5, v8
  v_lshlrev_b32 v5, 4, v5
  v_mad_u32_u24 v139, v7, s30, v5
  v_mad_u32_u24 v7, v8, s31, s31
  v_lshrrev_b32 v7, 16, v7
  v_mad_i32_i24 v139, v7, -8, v139
  v_subrev_u32 v7, 24, v8
  v_lshrrev_b32 v7, 31, v7
  v_lshl_or_b32 v14, v7, 1, v14
  v_sub_u32 v7, 120, v8
  v_lshrrev_b32 v7, 31, v7
  v_lshl_or_b32 v14, v7, 5, v14
  s_sub_u32 s48, s35, 147840
  s_add_u32 s49, s58, 116736
  v_lshrrev_b32 v8, s40, v14
  v_bfe_i32 v200, v8, 0, 1
  v_add_u32 v204, s48, v138
  v_or_b32 v204, v204, v200
  v_or_b32 v200, v200, v138
  v_bfe_i32 v201, v8, 1, 1
  v_add_u32 v205, s48, v139
  v_or_b32 v205, v205, v201
  v_or_b32 v201, v201, v139
  v_bfe_i32 v202, v8, 2, 1
  v_add_u32 v206, s48, v140
  v_or_b32 v206, v206, v202
  v_or_b32 v202, v202, v140
  v_bfe_i32 v203, v8, 3, 1
  v_add_u32 v207, s48, v141
  v_or_b32 v207, v207, v203
  v_or_b32 v203, v203, v141
  s_add_u32 m0, s49, 0
  s_nop 0
  buffer_load_dwordx4 v204, s[4:7], 0 offen lds
  s_add_u32 m0, s49, 4096
  s_nop 0
  buffer_load_dwordx4 v205, s[4:7], 0 offen lds
  s_waitcnt lgkmcnt(0)
  s_barrier
  s_add_u32 m0, s49, 8192
  s_nop 0
  buffer_load_dwordx4 v206, s[4:7], 0 offen lds
  s_add_u32 m0, s49, 12288
  s_nop 0
  buffer_load_dwordx4 v207, s[4:7], 0 offen lds
  s_add_u32 m0, s49, 16240
  s_add_u32 s31, s48, 516096
  buffer_load_dwordx4 v200, s[4:7], s31 offen lds
  s_add_u32 m0, s49, 20336
  s_add_u32 s31, s48, 516096
  buffer_load_dwordx4 v201, s[4:7], s31 offen lds
  s_add_u32 m0, s49, 24432
  s_add_u32 s31, s48, 516096
  buffer_load_dwordx4 v202, s[4:7], s31 offen lds
  s_add_u32 m0, s49, 28528
  s_add_u32 s31, s48, 516096
  buffer_load_dwordx4 v203, s[4:7], s31 offen lds
  s_call_b64 s[24:25], L_setup
  s_waitcnt vmcnt(8)
  s_barrier
  s_add_u32 m0, s49, 32480
  s_add_u32 s31, s48, 1032192
  buffer_load_dwordx4 v200, s[4:7], s31 offen lds
  s_add_u32 m0, s49, 36576
  s_add_u32 s31, s48, 1032192
  buffer_load_dwordx4 v201, s[4:7], s31 offen lds
  s_add_u32 m0, s49, 40672
  s_add_u32 s31, s48, 1032192
  buffer_load_dwordx4 v202, s[4:7], s31 offen lds
  s_cmp_ge_u32 s19, 2
  s_cbranch_scc1 L_sk_8
  s_add_u32 m0, s49, 44768
  s_add_u32 s31, s48, 1032192
  buffer_load_dwordx4 v203, s[4:7], s31 offen lds
L_sk_8:
  s_add_u32 s30, s29, 64
  s_mul_i32 s31, s30, 171
  s_lshr_b32 s31, s31, 10
  s_mul_i32 s32, s31, 6
  s_sub_u32 s32, s30, s32
  s_add_u32 s32, s32, s3
  s_mul_i32 s36, s31, 1179648
  s_mul_i32 s33, s32, 1536
  s_add_u32 s36, s36, s33
  s_cmp_eq_u32 s32, 0
  s_cselect_b32 s41, 0, 8
  s_cmp_eq_u32 s32, 47
  s_cselect_b32 s41, 4, s41
  s_sub_u32 s48, s36, 147840
  s_add_u32 s49, s58, 0
  v_lshrrev_b32 v8, s41, v14
  v_bfe_i32 v200, v8, 0, 1
  v_add_u32 v204, s48, v138
  v_or_b32 v204, v204, v200
  v_or_b32 v200, v200, v138
  v_bfe_i32 v201, v8, 1, 1
  v_add_u32 v205, s48, v139
  v_or_b32 v205, v205, v201
  v_or_b32 v201, v201, v139
  v_bfe_i32 v202, v8, 2, 1
  v_add_u32 v206, s48, v140
  v_or_b32 v206, v206, v202
  v_or_b32 v202, v202, v140
  v_bfe_i32 v203, v8, 3, 1
  v_add_u32 v207, s48, v141
  v_or_b32 v207, v207, v203
  v_or_b32 v203, v203, v141
  s_add_u32 m0, s49, 0
  s_nop 0
  buffer_load_dwordx4 v204, s[4:7], 0 offen lds
  s_add_u32 m0, s49, 4096
  s_nop 0
  buffer_load_dwordx4 v205, s[4:7], 0 offen lds
  s_add_u32 m0, s49, 8192
  s_nop 0
  buffer_load_dwordx4 v206, s[4:7], 0 offen lds
  s_add_u32 m0, s49, 12288
  s_nop 0
  buffer_load_dwordx4 v207, s[4:7], 0 offen lds
  s_add_u32 m0, s49, 16240
  s_add_u32 s31, s48, 516096
  buffer_load_dwordx4 v200, s[4:7], s31 offen lds
  s_add_u32 m0, s49, 20336
  s_add_u32 s31, s48, 516096
  buffer_load_dwordx4 v201, s[4:7], s31 offen lds
  s_add_u32 m0, s49, 24432
  s_add_u32 s31, s48, 516096
  buffer_load_dwordx4 v202, s[4:7], s31 offen lds
  s_add_u32 m0, s49, 28528
  s_add_u32 s31, s48, 516096
  buffer_load_dwordx4 v203, s[4:7], s31 offen lds
  s_add_u32 m0, s49, 32480
  s_add_u32 s31, s48, 1032192
  buffer_load_dwordx4 v200, s[4:7], s31 offen lds
  s_add_u32 m0, s49, 36576
  s_add_u32 s31, s48, 1032192
  buffer_load_dwordx4 v201, s[4:7], s31 offen lds
  s_add_u32 m0, s49, 40672
  s_add_u32 s31, s48, 1032192
  buffer_load_dwordx4 v202, s[4:7], s31 offen lds
  s_cmp_ge_u32 s19, 2
  s_cbranch_scc1 L_sk_9
  s_add_u32 m0, s49, 44768
  s_add_u32 s31, s48, 1032192
  buffer_load_dwordx4 v203, s[4:7], s31 offen lds
L_sk_9:
  s_call_b64 s[24:25], L_setupc
  v_add_u32 v142, 116736, v9
  s_call_b64 s[24:25], L_setup2
  s_cmp_ge_u32 s19, 2
  s_cbranch_scc1 L_wv_10
  s_waitcnt vmcnt(12) lgkmcnt(0)
  s_branch L_wv_11
L_wv_10:
  s_waitcnt vmcnt(11) lgkmcnt(0)
L_wv_11:
  s_cmp_lg_u32 s28, 7
  s_cbranch_scc1 L_wpf_12
  s_cmp_ge_u32 s29, 18
  s_cbranch_scc1 L_wpf_12
  s_cmp_lt_u32 s29, 9
  s_cselect_b32 s30, s96, s98
  s_cselect_b32 s31, s97, s99
  s_cselect_b32 s32, 0, 9
  s_sub_u32 s32, s29, s32
  s_lshl_b32 s32, s32, 13
  v_lshl_add_u32 v5, v4, 3, s32
  global_load_dword v16, v5, s[30:31]
L_wpf_12:
  s_barrier
  s_call_b64 s[24:25], L_core
  v_add_u32 v8, 116736, v15
  ds_read_b64 v[208:209], v8 offset:0
  ds_read_b64 v[210:211], v8 offset:8
  ds_read_b64 v[212:213], v8 offset:32
  ds_read_b64 v[214:215], v8 offset:40
  ds_read_b64 v[216:217], v8 offset:64
  ds_read_b64 v[218:219], v8 offset:72
  ds_read_b64 v[220:221], v8 offset:96
  ds_read_b64 v[222:223], v8 offset:104
  ds_read_b64 v[224:225], v8 offset:128
  ds_read_b64 v[226:227], v8 offset:136
  ds_read_b64 v[228:229], v8 offset:160
  ds_read_b64 v[230:231], v8 offset:168
  s_call_b64 s[24:25], L_stats
  s_call_b64 s[24:25], L_setup3
  s_waitcnt vmcnt(0)
  s_barrier
  s_setprio 2
  ds_read_b128 v[40:43], v143 offset:0
  ds_read_b128 v[44:47], v143 offset:1024
  ds_read_b128 v[48:51], v143 offset:2048
  ds_read_b128 v[52:55], v143 offset:3072
  s_sub_u32 s48, s37, 147840
  s_add_u32 s49, s58, 47104
  v_lshrrev_b32 v8, s42, v14
  v_bfe_i32 v200, v8, 0, 1
  v_or_b32 v200, v200, v138
  v_bfe_i32 v201, v8, 1, 1
  v_or_b32 v201, v201, v139
  v_bfe_i32 v202, v8, 2, 1
  v_or_b32 v202, v202, v140
  v_bfe_i32 v203, v8, 3, 1
  v_or_b32 v203, v203, v141
  s_barrier
  s_add_u32 m0, s49, 28528
  s_add_u32 s31, s48, 516096
  buffer_load_dwordx4 v203, s[4:7], s31 offen lds
  s_add_u32 m0, s49, 32480
  s_add_u32 s31, s48, 1032192
  buffer_load_dwordx4 v200, s[4:7], s31 offen lds
  s_add_u32 m0, s49, 36576
  s_add_u32 s31, s48, 1032192
  buffer_load_dwordx4 v201, s[4:7], s31 offen lds
  s_add_u32 m0, s49, 40672
  s_add_u32 s31, s48, 1032192
  buffer_load_dwordx4 v202, s[4:7], s31 offen lds
  s_cmp_ge_u32 s19, 2
  s_cbranch_scc1 L_sk_13
  s_add_u32 m0, s49, 44768
  s_add_u32 s31, s48, 1032192
  buffer_load_dwordx4 v203, s[4:7], s31 offen lds
L_sk_13:
  s_setprio 0
  v_add_u32 v5, 139264, v10
  s_call_b64 s[24:25], L_norm
  v_mfma_f32_32x32x8_bf16 v[144:159], v[64:65], v[64:65], 0
  v_mfma_f32_32x32x8_bf16 v[160:175], v[64:65], v[64:65], 0
  v_mfma_f32_32x32x8_bf16 v[176:191], v[64:65], v[64:65], 0
  v_add_u32 v142, 47104, v9
  s_waitcnt vmcnt(0)
  s_barrier
  v_add_u32 v8, 139264, v12
  ds_read_b128 v[16:19], v8 offset:0
  ds_read_b128 v[20:23], v8 offset:1024
  ds_read_b128 v[24:27], v8 offset:2048
  ds_read_b128 v[28:31], v8 offset:3072
  ds_read_b128 v[32:35], v8 offset:4096
  ds_read_b128 v[36:39], v8 offset:5120
  s_call_b64 s[24:25], L_core
  v_add_u32 v8, 47104, v15
  ds_read_b64 v[232:233], v8 offset:0
  ds_read_b64 v[234:235], v8 offset:8
  ds_read_b64 v[236:237], v8 offset:32
  ds_read_b64 v[238:239], v8 offset:40
  ds_read_b64 v[240:241], v8 offset:64
  ds_read_b64 v[242:243], v8 offset:72
  ds_read_b64 v[244:245], v8 offset:96
  ds_read_b64 v[246:247], v8 offset:104
  ds_read_b64 v[248:249], v8 offset:128
  ds_read_b64 v[250:251], v8 offset:136
  ds_read_b64 v[252:253], v8 offset:160
  ds_read_b64 v[254:255], v8 offset:168
  s_call_b64 s[24:25], L_stats
  s_waitcnt vmcnt(0)
  s_barrier
  s_setprio 2
  ds_read_b128 v[40:43], v143 offset:0
  ds_read_b128 v[44:47], v143 offset:1024
  ds_read_b128 v[48:51], v143 offset:2048
  ds_read_b128 v[52:55], v143 offset:3072
  s_mul_i32 s30, s18, 4
  s_add_u32 s30, s30, s16
  s_add_u32 m0, s59, 49152
  s_nop 0
  buffer_load_dwordx4 v11, s[12:15], s30 offen lds
  s_add_u32 m0, s59, 50176
  s_add_u32 s30, s30, s17
  buffer_load_dwordx4 v11, s[12:15], s30 offen lds
  s_add_u32 m0, s59, 51200
  s_add_u32 s30, s30, s17
  buffer_load_dwordx4 v11, s[12:15], s30 offen lds
  s_mul_i32 s30, s18, 5
  s_add_u32 s30, s30, s16
  s_add_u32 m0, s59, 61440
  s_nop 0
  buffer_load_dwordx4 v11, s[12:15], s30 offen lds
  s_add_u32 m0, s59, 62464
  s_add_u32 s30, s30, s17
  buffer_load_dwordx4 v11, s[12:15], s30 offen lds
  s_add_u32 m0, s59, 63488
  s_add_u32 s30, s30, s17
  buffer_load_dwordx4 v11, s[12:15], s30 offen lds
  s_setprio 0
  v_add_u32 v5, 75776, v10
  s_call_b64 s[24:25], L_norm
  s_waitcnt vmcnt(0)
  s_barrier
  v_add_u32 v8, 75776, v12
  ds_read_b128 v[40:43], v8 offset:0
  ds_read_b128 v[44:47], v8 offset:1024
  ds_read_b128 v[48:51], v8 offset:2048
  ds_read_b128 v[52:55], v8 offset:3072
  ds_read_b128 v[56:59], v8 offset:4096
  ds_read_b128 v[60:63], v8 offset:5120
L_ffn:
  v_lshlrev_b32 v64, 16, v208
  v_and_b32 v65, 0xffff0000, v208
  v_lshlrev_b32 v66, 16, v209
  v_and_b32 v67, 0xffff0000, v209
  v_lshlrev_b32 v68, 16, v210
  v_and_b32 v69, 0xffff0000, v210
  v_lshlrev_b32 v70, 16, v211
  v_and_b32 v71, 0xffff0000, v211
  v_lshlrev_b32 v72, 16, v212
  v_and_b32 v73, 0xffff0000, v212
  v_lshlrev_b32 v74, 16, v213
  v_and_b32 v75, 0xffff0000, v213
  v_lshlrev_b32 v76, 16, v214
  v_and_b32 v77, 0xffff0000, v214
  v_lshlrev_b32 v78, 16, v215
  v_and_b32 v79, 0xffff0000, v215
  v_lshlrev_b32 v80, 16, v216
  v_and_b32 v81, 0xffff0000, v216
  v_lshlrev_b32 v82, 16, v217
  v_and_b32 v83, 0xffff0000, v217
  v_lshlrev_b32 v84, 16, v218
  v_and_b32 v85, 0xffff0000, v218
  v_lshlrev_b32 v86, 16, v219
  v_and_b32 v87, 0xffff0000, v219
  v_lshlrev_b32 v88, 16, v220
  v_and_b32 v89, 0xffff0000, v220
  v_lshlrev_b32 v90, 16, v221
  v_and_b32 v91, 0xffff0000, v221
  v_lshlrev_b32 v92, 16, v222
  v_and_b32 v93, 0xffff0000, v222
  v_lshlrev_b32 v94, 16, v223
  v_and_b32 v95, 0xffff0000, v223
  v_lshlrev_b32 v96, 16, v224
  v_and_b32 v97, 0xffff0000, v224
  v_lshlrev_b32 v98, 16, v225
  v_and_b32 v99, 0xffff0000, v225
  v_lshlrev_b32 v100, 16, v226
  v_and_b32 v101, 0xffff0000, v226
  v_lshlrev_b32 v102, 16, v227
  v_and_b32 v103, 0xffff0000, v227
  v_lshlrev_b32 v104, 16, v228
  v_and_b32 v105, 0xffff0000, v228
  v_lshlrev_b32 v106, 16, v229
  v_and_b32 v107, 0xffff0000, v229
  v_lshlrev_b32 v108, 16, v230
  v_and_b32 v109, 0xffff0000, v230
  v_lshlrev_b32 v110, 16, v231
  v_and_b32 v111, 0xffff0000, v231
  ds_read_b64_tr_b16 v[208:209], v1 offset:0
  ds_read_b64_tr_b16 v[210:211], v1 offset:256
  ds_read_b64_tr_b16 v[212:213], v1 offset:1024
  ds_read_b64_tr_b16 v[214:215], v1 offset:1280
  ds_read_b64_tr_b16 v[216:217], v1 offset:2048
  ds_read_b64_tr_b16 v[218:219], v1 offset:2304
  ds_read_b64_tr_b16 v[220:221], v1 offset:3072
  ds_read_b64_tr_b16 v[222:223], v1 offset:3328
  ds_read_b64_tr_b16 v[224:225], v1 offset:4096
  ds_read_b64_tr_b16 v[226:227], v1 offset:4352
  ds_read_b64_tr_b16 v[228:229], v1 offset:5120
  ds_read_b64_tr_b16 v[230:231], v1 offset:5376
  v_lshlrev_b32 v112, 16, v232
  v_and_b32 v113, 0xffff0000, v232
  v_lshlrev_b32 v114, 16, v233
  v_and_b32 v115, 0xffff0000, v233
  v_lshlrev_b32 v116, 16, v234
  v_and_b32 v117, 0xffff0000, v234
  v_lshlrev_b32 v118, 16, v235
  v_and_b32 v119, 0xffff0000, v235
  v_lshlrev_b32 v120, 16, v236
  v_and_b32 v121, 0xffff0000, v236
  v_lshlrev_b32 v122, 16, v237
  v_and_b32 v123, 0xffff0000, v237
  v_lshlrev_b32 v124, 16, v238
  v_and_b32 v125, 0xffff0000, v238
  v_lshlrev_b32 v126, 16, v239
  v_and_b32 v127, 0xffff0000, v239
  v_lshlrev_b32 v128, 16, v240
  v_and_b32 v129, 0xffff0000, v240
  v_lshlrev_b32 v130, 16, v241
  v_and_b32 v131, 0xffff0000, v241
  v_lshlrev_b32 v132, 16, v242
  v_and_b32 v133, 0xffff0000, v242
  v_lshlrev_b32 v134, 16, v243
  v_and_b32 v135, 0xffff0000, v243
  v_lshlrev_b32 v136, 16, v244
  v_and_b32 v137, 0xffff0000, v244
  v_lshlrev_b32 v138, 16, v245
  v_and_b32 v139, 0xffff0000, v245
  v_lshlrev_b32 v140, 16, v246
  v_and_b32 v141, 0xffff0000, v246
  v_lshlrev_b32 v142, 16, v247
  v_and_b32 v143, 0xffff0000, v247
  v_lshlrev_b32 v144, 16, v248
  v_and_b32 v145, 0xffff0000, v248
  v_lshlrev_b32 v146, 16, v249
  v_and_b32 v147, 0xffff0000, v249
  v_lshlrev_b32 v148, 16, v250
  v_and_b32 v149, 0xffff0000, v250
  v_lshlrev_b32 v150, 16, v251
  v_and_b32 v151, 0xffff0000, v251
  v_lshlrev_b32 v152, 16, v252
  v_and_b32 v153, 0xffff0000, v252
  v_lshlrev_b32 v154, 16, v253
  v_and_b32 v155, 0xffff0000, v253
  v_lshlrev_b32 v156, 16, v254
  v_and_b32 v157, 0xffff0000, v254
  v_lshlrev_b32 v158, 16, v255
  v_and_b32 v159, 0xffff0000, v255
  v_bfe_u32 v5, v0, 4, 1
  v_mul_u32_u24 v5, 160, v5
  v_sub_u32 v14, v3, v5
  s_waitcnt lgkmcnt(0)
  v_mfma_f32_32x32x16_bf16 v[160:175], v[208:211], v[16:19], 0
  v_mfma_f32_32x32x16_bf16 v[160:175], v[212:215], v[20:23], v[160:175]
  v_mfma_f32_32x32x16_bf16 v[160:175], v[216:219], v[24:27], v[160:175]
  v_mfma_f32_32x32x16_bf16 v[160:175], v[220:223], v[28:31], v[160:175]
  v_mfma_f32_32x32x16_bf16 v[160:175], v[224:227], v[32:35], v[160:175]
  v_mfma_f32_32x32x16_bf16 v[160:175], v[228:231], v[36:39], v[160:175]
  ds_read_b64_tr_b16 v[208:209], v1 offset:49152
  ds_read_b64_tr_b16 v[210:211], v1 offset:49408
  ds_read_b64_tr_b16 v[212:213], v1 offset:50176
  ds_read_b64_tr_b16 v[214:215], v1 offset:50432
  ds_read_b64_tr_b16 v[216:217], v1 offset:51200
  ds_read_b64_tr_b16 v[218:219], v1 offset:51456
  ds_read_b64_tr_b16 v[220:221], v1 offset:52224
  ds_read_b64_tr_b16 v[222:223], v1 offset:52480
  ds_read_b64_tr_b16 v[224:225], v1 offset:53248
  ds_read_b64_tr_b16 v[226:227], v1 offset:53504
  ds_read_b64_tr_b16 v[228:229], v1 offset:54272
  ds_read_b64_tr_b16 v[230:231], v1 offset:54528
  v_pk_fma_f32 v[192:193], v[160:161], v[160:161], s[44:45]
  v_pk_fma_f32 v[194:195], v[162:163], v[162:163], s[44:45]
  v_pk_fma_f32 v[196:197], v[164:165], v[164:165], s[44:45]
  v_pk_fma_f32 v[198:199], v[166:167], v[166:167], s[44:45]
  v_pk_fma_f32 v[200:201], v[168:169], v[168:169], s[44:45]
  v_pk_fma_f32 v[202:203], v[170:171], v[170:171], s[44:45]
  v_pk_fma_f32 v[204:205], v[172:173], v[172:173], s[44:45]
  v_pk_fma_f32 v[206:207], v[174:175], v[174:175], s[44:45]
  v_pk_mul_f32 v[192:193], v[192:193], v[160:161] neg_lo:[1,0] neg_hi:[1,0]
  v_pk_mul_f32 v[194:195], v[194:195], v[162:163] neg_lo:[1,0] neg_hi:[1,0]
  v_pk_mul_f32 v[196:197], v[196:197], v[164:165] neg_lo:[1,0] neg_hi:[1,0]
  v_pk_mul_f32 v[198:199], v[198:199], v[166:167] neg_lo:[1,0] neg_hi:[1,0]
  v_pk_mul_f32 v[200:201], v[200:201], v[168:169] neg_lo:[1,0] neg_hi:[1,0]
  v_pk_mul_f32 v[202:203], v[202:203], v[170:171] neg_lo:[1,0] neg_hi:[1,0]
  v_pk_mul_f32 v[204:205], v[204:205], v[172:173] neg_lo:[1,0] neg_hi:[1,0]
  v_pk_mul_f32 v[206:207], v[206:207], v[174:175] neg_lo:[1,0] neg_hi:[1,0]
  v_exp_f32 v192, v192
  v_exp_f32 v193, v193
  v_exp_f32 v194, v194
  v_exp_f32 v195, v195
  v_exp_f32 v196, v196
  v_exp_f32 v197, v197
  v_exp_f32 v198, v198
  v_exp_f32 v199, v199
  v_exp_f32 v200, v200
  v_exp_f32 v201, v201
  v_exp_f32 v202, v202
  v_exp_f32 v203, v203
  v_exp_f32 v204, v204
  v_exp_f32 v205, v205
  v_exp_f32 v206, v206
  v_exp_f32 v207, v207
  ds_read_b64_tr_b16 v[232:233], v2 offset:6144
  ds_read_b64_tr_b16 v[234:235], v2 offset:6912
  ds_read_b64_tr_b16 v[236:237], v2 offset:6208
  ds_read_b64_tr_b16 v[238:239], v2 offset:6976
  ds_read_b64_tr_b16 v[240:241], v2 offset:6272
  ds_read_b64_tr_b16 v[242:243], v2 offset:7040
  ds_read_b64_tr_b16 v[244:245], v2 offset:9216
  ds_read_b64_tr_b16 v[246:247], v2 offset:9984
  ds_read_b64_tr_b16 v[248:249], v2 offset:9280
  ds_read_b64_tr_b16 v[250:251], v2 offset:10048
  ds_read_b64_tr_b16 v[252:253], v2 offset:9344
  ds_read_b64_tr_b16 v[254:255], v2 offset:10112
  s_mul_i32 s100, s3, 1
  s_add_u32 s100, s100, 9
  s_mul_i32 s101, s100, 12288
  s_add_u32 s101, s101, s59
  s_mul_i32 s100, s100, s18
  s_mov_b32 m0, s101
  s_add_u32 s100, s100, s16
  buffer_load_dwordx4 v11, s[12:15], s100 offen lds
  v_pk_fma_f32 v[192:193], v[192:193], s[46:47], s[46:47]
  v_pk_fma_f32 v[194:195], v[194:195], s[46:47], s[46:47]
  v_pk_fma_f32 v[196:197], v[196:197], s[46:47], s[46:47]
  v_pk_fma_f32 v[198:199], v[198:199], s[46:47], s[46:47]
  v_pk_fma_f32 v[200:201], v[200:201], s[46:47], s[46:47]
  v_pk_fma_f32 v[202:203], v[202:203], s[46:47], s[46:47]
  v_pk_fma_f32 v[204:205], v[204:205], s[46:47], s[46:47]
  v_pk_fma_f32 v[206:207], v[206:207], s[46:47], s[46:47]
  s_waitcnt lgkmcnt(12)
  v_mfma_f32_32x32x16_bf16 v[176:191], v[208:211], v[16:19], 0
  v_rcp_f32 v192, v192
  v_rcp_f32 v193, v193
  v_rcp_f32 v194, v194
  v_mfma_f32_32x32x16_bf16 v[176:191], v[212:215], v[20:23], v[176:191]
  v_rcp_f32 v195, v195
  v_rcp_f32 v196, v196
  v_rcp_f32 v197, v197
  v_mfma_f32_32x32x16_bf16 v[176:191], v[216:219], v[24:27], v[176:191]
  v_rcp_f32 v198, v198
  v_rcp_f32 v199, v199
  v_rcp_f32 v200, v200
  v_mfma_f32_32x32x16_bf16 v[176:191], v[220:223], v[28:31], v[176:191]
  v_rcp_f32 v201, v201
  v_rcp_f32 v202, v202
  v_rcp_f32 v203, v203
  v_mfma_f32_32x32x16_bf16 v[176:191], v[224:227], v[32:35], v[176:191]
  v_rcp_f32 v204, v204
  v_rcp_f32 v205, v205
  v_mul_f32 v160, v160, v192
  v_mul_f32 v161, v161, v193
  v_mfma_f32_32x32x16_bf16 v[176:191], v[228:231], v[36:39], v[176:191]
  v_rcp_f32 v206, v206
  v_rcp_f32 v207, v207
  v_mul_f32 v162, v162, v194
  v_mul_f32 v163, v163, v195
  v_add_u32 v1, 12288, v1
  ds_read_b64_tr_b16 v[208:209], v1 offset:49152
  ds_read_b64_tr_b16 v[210:211], v1 offset:49408
  ds_read_b64_tr_b16 v[212:213], v1 offset:50176
  ds_read_b64_tr_b16 v[214:215], v1 offset:50432
  ds_read_b64_tr_b16 v[216:217], v1 offset:51200
  ds_read_b64_tr_b16 v[218:219], v1 offset:51456
  ds_read_b64_tr_b16 v[220:221], v1 offset:52224
  ds_read_b64_tr_b16 v[222:223], v1 offset:52480
  ds_read_b64_tr_b16 v[224:225], v1 offset:53248
  ds_read_b64_tr_b16 v[226:227], v1 offset:53504
  ds_read_b64_tr_b16 v[228:229], v1 offset:54272
  ds_read_b64_tr_b16 v[230:231], v1 offset:54528
  s_add_u32 m0, s101, 1024
  s_add_u32 s100, s100, s17
  buffer_load_dwordx4 v11, s[12:15], s100 offen lds
  v_pk_mul_f32 v[164:165], v[164:165], v[196:197]
  v_pk_mul_f32 v[166:167], v[166:167], v[198:199]
  v_pk_mul_f32 v[168:169], v[168:169], v[200:201]
  v_pk_mul_f32 v[170:171], v[170:171], v[202:203]
  v_pk_mul_f32 v[172:173], v[172:173], v[204:205]
  v_pk_mul_f32 v[174:175], v[174:175], v[206:207]
  v_cvt_pk_bf16_f32 v160, v160, v161
  v_cvt_pk_bf16_f32 v161, v162, v163
  v_cvt_pk_bf16_f32 v162, v164, v165
  v_cvt_pk_bf16_f32 v163, v166, v167
  v_pk_fma_f32 v[192:193], v[176:177], v[176:177], s[44:45]
  v_pk_fma_f32 v[194:195], v[178:179], v[178:179], s[44:45]
  v_pk_fma_f32 v[196:197], v[180:181], v[180:181], s[44:45]
  v_pk_fma_f32 v[198:199], v[182:183], v[182:183], s[44:45]
  v_pk_fma_f32 v[200:201], v[184:185], v[184:185], s[44:45]
  v_pk_fma_f32 v[202:203], v[186:187], v[186:187], s[44:45]
  v_pk_fma_f32 v[204:205], v[188:189], v[188:189], s[44:45]
  v_pk_fma_f32 v[206:207], v[190:191], v[190:191], s[44:45]
  v_pk_mul_f32 v[192:193], v[192:193], v[176:177] neg_lo:[1,0] neg_hi:[1,0]
  v_pk_mul_f32 v[194:195], v[194:195], v[178:179] neg_lo:[1,0] neg_hi:[1,0]
  v_pk_mul_f32 v[196:197], v[196:197], v[180:181] neg_lo:[1,0] neg_hi:[1,0]
  v_pk_mul_f32 v[198:199], v[198:199], v[182:183] neg_lo:[1,0] neg_hi:[1,0]
  v_pk_mul_f32 v[200:201], v[200:201], v[184:185] neg_lo:[1,0] neg_hi:[1,0]
  v_pk_mul_f32 v[202:203], v[202:203], v[186:187] neg_lo:[1,0] neg_hi:[1,0]
  v_pk_mul_f32 v[204:205], v[204:205], v[188:189] neg_lo:[1,0] neg_hi:[1,0]
  v_pk_mul_f32 v[206:207], v[206:207], v[190:191] neg_lo:[1,0] neg_hi:[1,0]
  s_waitcnt lgkmcnt(12)
  v_mfma_f32_32x32x16_bf16 v[64:79], v[232:235], v[160:163], v[64:79]
  v_exp_f32 v192, v192
  v_exp_f32 v193, v193
  v_cvt_pk_bf16_f32 v168, v168, v169
  v_cvt_pk_bf16_f32 v169, v170, v171
  v_mfma_f32_32x32x16_bf16 v[80:95], v[236:239], v[160:163], v[80:95]
  v_exp_f32 v194, v194
  v_exp_f32 v195, v195
  v_cvt_pk_bf16_f32 v170, v172, v173
  v_cvt_pk_bf16_f32 v171, v174, v175
  v_mfma_f32_32x32x16_bf16 v[96:111], v[240:243], v[160:163], v[96:111]
  v_exp_f32 v196, v196
  v_exp_f32 v197, v197
  v_exp_f32 v198, v198
  v_mfma_f32_32x32x16_bf16 v[64:79], v[244:247], v[168:171], v[64:79]
  v_exp_f32 v199, v199
  v_exp_f32 v200, v200
  v_exp_f32 v201, v201
  v_mfma_f32_32x32x16_bf16 v[80:95], v[248:251], v[168:171], v[80:95]
  v_exp_f32 v202, v202
  v_exp_f32 v203, v203
  v_exp_f32 v204, v204
  v_mfma_f32_32x32x16_bf16 v[96:111], v[252:255], v[168:171], v[96:111]
  v_exp_f32 v205, v205
  v_exp_f32 v206, v206
  v_exp_f32 v207, v207
  ds_read_b64_tr_b16 v[232:233], v2 offset:55296
  ds_read_b64_tr_b16 v[234:235], v2 offset:56064
  ds_read_b64_tr_b16 v[236:237], v2 offset:55360
  ds_read_b64_tr_b16 v[238:239], v2 offset:56128
  ds_read_b64_tr_b16 v[240:241], v2 offset:55424
  ds_read_b64_tr_b16 v[242:243], v2 offset:56192
  ds_read_b64_tr_b16 v[244:245], v2 offset:58368
  ds_read_b64_tr_b16 v[246:247], v2 offset:59136
  ds_read_b64_tr_b16 v[248:249], v2 offset:58432
  ds_read_b64_tr_b16 v[250:251], v2 offset:59200
  ds_read_b64_tr_b16 v[252:253], v2 offset:58496
  ds_read_b64_tr_b16 v[254:255], v2 offset:59264
  s_add_u32 m0, s101, 2048
  s_add_u32 s100, s100, s17
  buffer_load_dwordx4 v11, s[12:15], s100 offen lds
  v_pk_fma_f32 v[192:193], v[192:193], s[46:47], s[46:47]
  v_pk_fma_f32 v[194:195], v[194:195], s[46:47], s[46:47]
  v_pk_fma_f32 v[196:197], v[196:197], s[46:47], s[46:47]
  v_pk_fma_f32 v[198:199], v[198:199], s[46:47], s[46:47]
  v_pk_fma_f32 v[200:201], v[200:201], s[46:47], s[46:47]
  v_pk_fma_f32 v[202:203], v[202:203], s[46:47], s[46:47]
  v_pk_fma_f32 v[204:205], v[204:205], s[46:47], s[46:47]
  v_pk_fma_f32 v[206:207], v[206:207], s[46:47], s[46:47]
  s_waitcnt lgkmcnt(12)
  v_mfma_f32_32x32x16_bf16 v[160:175], v[208:211], v[16:19], 0
  v_rcp_f32 v192, v192
  v_rcp_f32 v193, v193
  v_rcp_f32 v194, v194
  v_mfma_f32_32x32x16_bf16 v[160:175], v[212:215], v[20:23], v[160:175]
  v_rcp_f32 v195, v195
  v_rcp_f32 v196, v196
  v_rcp_f32 v197, v197
  v_mfma_f32_32x32x16_bf16 v[160:175], v[216:219], v[24:27], v[160:175]
  v_rcp_f32 v198, v198
  v_rcp_f32 v199, v199
  v_rcp_f32 v200, v200
  v_mfma_f32_32x32x16_bf16 v[160:175], v[220:223], v[28:31], v[160:175]
  v_rcp_f32 v201, v201
  v_rcp_f32 v202, v202
  v_rcp_f32 v203, v203
  v_mfma_f32_32x32x16_bf16 v[160:175], v[224:227], v[32:35], v[160:175]
  v_rcp_f32 v204, v204
  v_rcp_f32 v205, v205
  v_mul_f32 v176, v176, v192
  v_mul_f32 v177, v177, v193
  v_mfma_f32_32x32x16_bf16 v[160:175], v[228:231], v[36:39], v[160:175]
  v_rcp_f32 v206, v206
  v_rcp_f32 v207, v207
  v_mul_f32 v178, v178, v194
  v_mul_f32 v179, v179, v195
  s_waitcnt vmcnt(0)
  s_barrier
  ds_read_b64_tr_b16 v[208:209], v1 offset:0
  ds_read_b64_tr_b16 v[210:211], v1 offset:256
  ds_read_b64_tr_b16 v[212:213], v1 offset:1024
  ds_read_b64_tr_b16 v[214:215], v1 offset:1280
  ds_read_b64_tr_b16 v[216:217], v1 offset:2048
  ds_read_b64_tr_b16 v[218:219], v1 offset:2304
  ds_read_b64_tr_b16 v[220:221], v1 offset:3072
  ds_read_b64_tr_b16 v[222:223], v1 offset:3328
  ds_read_b64_tr_b16 v[224:225], v1 offset:4096
  ds_read_b64_tr_b16 v[226:227], v1 offset:4352
  ds_read_b64_tr_b16 v[228:229], v1 offset:5120
  ds_read_b64_tr_b16 v[230:231], v1 offset:5376
  s_mul_i32 s100, s3, -5
  s_add_u32 s100, s100, 11
  s_mul_i32 s101, s100, 12288
  s_add_u32 s101, s101, s59
  s_mul_i32 s100, s100, s18
  s_mov_b32 m0, s101
  s_add_u32 s100, s100, s16
  buffer_load_dwordx4 v11, s[12:15], s100 offen lds
  v_pk_mul_f32 v[180:181], v[180:181], v[196:197]
  v_pk_mul_f32 v[182:183], v[182:183], v[198:199]
  v_pk_mul_f32 v[184:185], v[184:185], v[200:201]
  v_pk_mul_f32 v[186:187], v[186:187], v[202:203]
  v_pk_mul_f32 v[188:189], v[188:189], v[204:205]
  v_pk_mul_f32 v[190:191], v[190:191], v[206:207]
  v_cvt_pk_bf16_f32 v176, v176, v177
  v_cvt_pk_bf16_f32 v177, v178, v179
  v_cvt_pk_bf16_f32 v178, v180, v181
  v_cvt_pk_bf16_f32 v179, v182, v183
  v_pk_fma_f32 v[192:193], v[160:161], v[160:161], s[44:45]
  v_pk_fma_f32 v[194:195], v[162:163], v[162:163], s[44:45]
  v_pk_fma_f32 v[196:197], v[164:165], v[164:165], s[44:45]
  v_pk_fma_f32 v[198:199], v[166:167], v[166:167], s[44:45]
  v_pk_fma_f32 v[200:201], v[168:169], v[168:169], s[44:45]
  v_pk_fma_f32 v[202:203], v[170:171], v[170:171], s[44:45]
  v_pk_fma_f32 v[204:205], v[172:173], v[172:173], s[44:45]
  v_pk_fma_f32 v[206:207], v[174:175], v[174:175], s[44:45]
  v_pk_mul_f32 v[192:193], v[192:193], v[160:161] neg_lo:[1,0] neg_hi:[1,0]
  v_pk_mul_f32 v[194:195], v[194:195], v[162:163] neg_lo:[1,0] neg_hi:[1,0]
  v_pk_mul_f32 v[196:197], v[196:197], v[164:165] neg_lo:[1,0] neg_hi:[1,0]
  v_pk_mul_f32 v[198:199], v[198:199], v[166:167] neg_lo:[1,0] neg_hi:[1,0]
  v_pk_mul_f32 v[200:201], v[200:201], v[168:169] neg_lo:[1,0] neg_hi:[1,0]
  v_pk_mul_f32 v[202:203], v[202:203], v[170:171] neg_lo:[1,0] neg_hi:[1,0]
  v_pk_mul_f32 v[204:205], v[204:205], v[172:173] neg_lo:[1,0] neg_hi:[1,0]
  v_pk_mul_f32 v[206:207], v[206:207], v[174:175] neg_lo:[1,0] neg_hi:[1,0]
  s_cmp_lt_u32 s28, 4
  s_cbranch_scc1 L_prio_14
  s_setprio 1
L_prio_14:
  s_waitcnt lgkmcnt(12)
  v_mfma_f32_32x32x16_bf16 v[64:79], v[232:235], v[176:179], v[64:79]
  v_exp_f32 v192, v192
  v_exp_f32 v193, v193
  v_cvt_pk_bf16_f32 v184, v184, v185
  v_cvt_pk_bf16_f32 v185, v186, v187
  v_mfma_f32_32x32x16_bf16 v[80:95], v[236:239], v[176:179], v[80:95]
  v_exp_f32 v194, v194
  v_exp_f32 v195, v195
  v_cvt_pk_bf16_f32 v186, v188, v189
  v_cvt_pk_bf16_f32 v187, v190, v191
  v_mfma_f32_32x32x16_bf16 v[96:111], v[240:243], v[176:179], v[96:111]
  v_exp_f32 v196, v196
  v_exp_f32 v197, v197
  v_exp_f32 v198, v198
  v_mfma_f32_32x32x16_bf16 v[64:79], v[244:247], v[184:187], v[64:79]
  v_exp_f32 v199, v199
  v_exp_f32 v200, v200
  v_exp_f32 v201, v201
  v_mfma_f32_32x32x16_bf16 v[80:95], v[248:251], v[184:187], v[80:95]
  v_exp_f32 v202, v202
  v_exp_f32 v203, v203
  v_exp_f32 v204, v204
  v_mfma_f32_32x32x16_bf16 v[96:111], v[252:255], v[184:187], v[96:111]
  v_exp_f32 v205, v205
  v_exp_f32 v206, v206
  v_exp_f32 v207, v207
  v_add_u32 v2, 12288, v2
  ds_read_b64_tr_b16 v[232:233], v2 offset:55296
  ds_read_b64_tr_b16 v[234:235], v2 offset:56064
  ds_read_b64_tr_b16 v[236:237], v2 offset:55360
  ds_read_b64_tr_b16 v[238:239], v2 offset:56128
  ds_read_b64_tr_b16 v[240:241], v2 offset:55424
  ds_read_b64_tr_b16 v[242:243], v2 offset:56192
  ds_read_b64_tr_b16 v[244:245], v2 offset:58368
  ds_read_b64_tr_b16 v[246:247], v2 offset:59136
  ds_read_b64_tr_b16 v[248:249], v2 offset:58432
  ds_read_b64_tr_b16 v[250:251], v2 offset:59200
  ds_read_b64_tr_b16 v[252:253], v2 offset:58496
  ds_read_b64_tr_b16 v[254:255], v2 offset:59264
  s_add_u32 m0, s101, 1024
  s_add_u32 s100, s100, s17
  buffer_load_dwordx4 v11, s[12:15], s100 offen lds
  v_pk_fma_f32 v[192:193], v[192:193], s[46:47], s[46:47]
  v_pk_fma_f32 v[194:195], v[194:195], s[46:47], s[46:47]
  v_pk_fma_f32 v[196:197], v[196:197], s[46:47], s[46:47]
  v_pk_fma_f32 v[198:199], v[198:199], s[46:47], s[46:47]
  v_pk_fma_f32 v[200:201], v[200:201], s[46:47], s[46:47]
  v_pk_fma_f32 v[202:203], v[202:203], s[46:47], s[46:47]
  v_pk_fma_f32 v[204:205], v[204:205], s[46:47], s[46:47]
  v_pk_fma_f32 v[206:207], v[206:207], s[46:47], s[46:47]
  s_waitcnt lgkmcnt(12)
  v_mfma_f32_32x32x16_bf16 v[176:191], v[208:211], v[16:19], 0
  v_rcp_f32 v192, v192
  v_rcp_f32 v193, v193
  v_rcp_f32 v194, v194
  v_mfma_f32_32x32x16_bf16 v[176:191], v[212:215], v[20:23], v[176:191]
  v_rcp_f32 v195, v195
  v_rcp_f32 v196, v196
  v_rcp_f32 v197, v197
  v_mfma_f32_32x32x16_bf16 v[176:191], v[216:219], v[24:27], v[176:191]
  v_rcp_f32 v198, v198
  v_rcp_f32 v199, v199
  v_rcp_f32 v200, v200
  v_mfma_f32_32x32x16_bf16 v[176:191], v[220:223], v[28:31], v[176:191]
  v_rcp_f32 v201, v201
  v_rcp_f32 v202, v202
  v_rcp_f32 v203, v203
  v_mfma_f32_32x32x16_bf16 v[176:191], v[224:227], v[32:35], v[176:191]
  v_rcp_f32 v204, v204
  v_rcp_f32 v205, v205
  v_mul_f32 v160, v160, v192
  v_mul_f32 v161, v161, v193
  v_mfma_f32_32x32x16_bf16 v[176:191], v[228:231], v[36:39], v[176:191]
  v_rcp_f32 v206, v206
  v_rcp_f32 v207, v207
  v_mul_f32 v162, v162, v194
  v_mul_f32 v163, v163, v195
  v_mul_f32 v164, v164, v196
  v_mul_f32 v165, v165, v197
  s_add_u32 m0, s101, 2048
  s_add_u32 s100, s100, s17
  buffer_load_dwordx4 v11, s[12:15], s100 offen lds
  v_pk_mul_f32 v[166:167], v[166:167], v[198:199]
  v_pk_mul_f32 v[168:169], v[168:169], v[200:201]
  v_pk_mul_f32 v[170:171], v[170:171], v[202:203]
  v_pk_mul_f32 v[172:173], v[172:173], v[204:205]
  v_pk_mul_f32 v[174:175], v[174:175], v[206:207]
  v_cvt_pk_bf16_f32 v160, v160, v161
  v_cvt_pk_bf16_f32 v161, v162, v163
  v_cvt_pk_bf16_f32 v162, v164, v165
  v_cvt_pk_bf16_f32 v163, v166, v167
  v_pk_fma_f32 v[192:193], v[176:177], v[176:177], s[44:45]
  v_pk_fma_f32 v[194:195], v[178:179], v[178:179], s[44:45]
  v_pk_fma_f32 v[196:197], v[180:181], v[180:181], s[44:45]
  v_pk_fma_f32 v[198:199], v[182:183], v[182:183], s[44:45]
  v_pk_fma_f32 v[200:201], v[184:185], v[184:185], s[44:45]
  v_pk_fma_f32 v[202:203], v[186:187], v[186:187], s[44:45]
  v_pk_fma_f32 v[204:205], v[188:189], v[188:189], s[44:45]
  v_pk_fma_f32 v[206:207], v[190:191], v[190:191], s[44:45]
  v_pk_mul_f32 v[192:193], v[192:193], v[176:177] neg_lo:[1,0] neg_hi:[1,0]
  v_pk_mul_f32 v[194:195], v[194:195], v[178:179] neg_lo:[1,0] neg_hi:[1,0]
  v_pk_mul_f32 v[196:197], v[196:197], v[180:181] neg_lo:[1,0] neg_hi:[1,0]
  v_pk_mul_f32 v[198:199], v[198:199], v[182:183] neg_lo:[1,0] neg_hi:[1,0]
  v_pk_mul_f32 v[200:201], v[200:201], v[184:185] neg_lo:[1,0] neg_hi:[1,0]
  v_pk_mul_f32 v[202:203], v[202:203], v[186:187] neg_lo:[1,0] neg_hi:[1,0]
  v_pk_mul_f32 v[204:205], v[204:205], v[188:189] neg_lo:[1,0] neg_hi:[1,0]
  v_pk_mul_f32 v[206:207], v[206:207], v[190:191] neg_lo:[1,0] neg_hi:[1,0]
  s_waitcnt lgkmcnt(0)
  v_mfma_f32_32x32x16_bf16 v[64:79], v[232:235], v[160:163], v[64:79]
  v_exp_f32 v192, v192
  v_exp_f32 v193, v193
  v_cvt_pk_bf16_f32 v168, v168, v169
  v_cvt_pk_bf16_f32 v169, v170, v171
  v_mfma_f32_32x32x16_bf16 v[80:95], v[236:239], v[160:163], v[80:95]
  v_exp_f32 v194, v194
  v_exp_f32 v195, v195
  v_cvt_pk_bf16_f32 v170, v172, v173
  v_cvt_pk_bf16_f32 v171, v174, v175
  v_mfma_f32_32x32x16_bf16 v[96:111], v[240:243], v[160:163], v[96:111]
  v_exp_f32 v196, v196
  v_exp_f32 v197, v197
  v_exp_f32 v198, v198
  v_mfma_f32_32x32x16_bf16 v[64:79], v[244:247], v[168:171], v[64:79]
  v_exp_f32 v199, v199
  v_exp_f32 v200, v200
  v_exp_f32 v201, v201
  v_mfma_f32_32x32x16_bf16 v[80:95], v[248:251], v[168:171], v[80:95]
  v_exp_f32 v202, v202
  v_exp_f32 v203, v203
  v_exp_f32 v204, v204
  v_mfma_f32_32x32x16_bf16 v[96:111], v[252:255], v[168:171], v[96:111]
  v_exp_f32 v205, v205
  v_exp_f32 v206, v206
  v_exp_f32 v207, v207
  ds_read_b64_tr_b16 v[232:233], v2 offset:6144
  ds_read_b64_tr_b16 v[234:235], v2 offset:6912
  ds_read_b64_tr_b16 v[236:237], v2 offset:6208
  ds_read_b64_tr_b16 v[238:239], v2 offset:6976
  ds_read_b64_tr_b16 v[240:241], v2 offset:6272
  ds_read_b64_tr_b16 v[242:243], v2 offset:7040
  ds_read_b64_tr_b16 v[244:245], v2 offset:9216
  ds_read_b64_tr_b16 v[246:247], v2 offset:9984
  ds_read_b64_tr_b16 v[248:249], v2 offset:9280
  ds_read_b64_tr_b16 v[250:251], v2 offset:10048
  ds_read_b64_tr_b16 v[252:253], v2 offset:9344
  ds_read_b64_tr_b16 v[254:255], v2 offset:10112
  s_mul_i32 s100, s3, 1
  s_add_u32 s100, s100, 7
  s_mul_i32 s101, s100, 12288
  s_add_u32 s101, s101, s59
  s_mul_i32 s100, s100, s18
  s_mov_b32 m0, s101
  s_add_u32 s100, s100, s16
  buffer_load_dwordx4 v11, s[12:15], s100 offen lds
  v_pk_fma_f32 v[192:193], v[192:193], s[46:47], s[46:47]
  v_pk_fma_f32 v[194:195], v[194:195], s[46:47], s[46:47]
  v_pk_fma_f32 v[196:197], v[196:197], s[46:47], s[46:47]
  v_pk_fma_f32 v[198:199], v[198:199], s[46:47], s[46:47]
  v_pk_fma_f32 v[200:201], v[200:201], s[46:47], s[46:47]
  v_pk_fma_f32 v[202:203], v[202:203], s[46:47], s[46:47]
  v_pk_fma_f32 v[204:205], v[204:205], s[46:47], s[46:47]
  v_pk_fma_f32 v[206:207], v[206:207], s[46:47], s[46:47]
  v_mfma_f32_32x32x16_bf16 v[160:175], v[208:211], v[40:43], 0
  v_rcp_f32 v192, v192
  v_rcp_f32 v193, v193
  v_rcp_f32 v194, v194
  v_mfma_f32_32x32x16_bf16 v[160:175], v[212:215], v[44:47], v[160:175]
  v_rcp_f32 v195, v195
  v_rcp_f32 v196, v196
  v_rcp_f32 v197, v197
  v_mfma_f32_32x32x16_bf16 v[160:175], v[216:219], v[48:51], v[160:175]
  v_rcp_f32 v198, v198
  v_rcp_f32 v199, v199
  v_rcp_f32 v200, v200
  v_mfma_f32_32x32x16_bf16 v[160:175], v[220:223], v[52:55], v[160:175]
  v_rcp_f32 v201, v201
  v_rcp_f32 v202, v202
  v_rcp_f32 v203, v203
  v_mfma_f32_32x32x16_bf16 v[160:175], v[224:227], v[56:59], v[160:175]
  v_rcp_f32 v204, v204
  v_rcp_f32 v205, v205
  v_mul_f32 v176, v176, v192
  v_mul_f32 v177, v177, v193
  v_mfma_f32_32x32x16_bf16 v[160:175], v[228:231], v[60:63], v[160:175]
  v_rcp_f32 v206, v206
  v_rcp_f32 v207, v207
  v_mul_f32 v178, v178, v194
  v_mul_f32 v179, v179, v195
  ds_read_b64_tr_b16 v[208:209], v1 offset:12288
  ds_read_b64_tr_b16 v[210:211], v1 offset:12544
  ds_read_b64_tr_b16 v[212:213], v1 offset:13312
  ds_read_b64_tr_b16 v[214:215], v1 offset:13568
  ds_read_b64_tr_b16 v[216:217], v1 offset:14336
  ds_read_b64_tr_b16 v[218:219], v1 offset:14592
  ds_read_b64_tr_b16 v[220:221], v1 offset:15360
  ds_read_b64_tr_b16 v[222:223], v1 offset:15616
  ds_read_b64_tr_b16 v[224:225], v1 offset:16384
  ds_read_b64_tr_b16 v[226:227], v1 offset:16640
  ds_read_b64_tr_b16 v[228:229], v1 offset:17408
  ds_read_b64_tr_b16 v[230:231], v1 offset:17664
  s_add_u32 m0, s101, 1024
  s_add_u32 s100, s100, s17
  buffer_load_dwordx4 v11, s[12:15], s100 offen lds
  v_pk_mul_f32 v[180:181], v[180:181], v[196:197]
  v_pk_mul_f32 v[182:183], v[182:183], v[198:199]
  v_pk_mul_f32 v[184:185], v[184:185], v[200:201]
  v_pk_mul_f32 v[186:187], v[186:187], v[202:203]
  v_pk_mul_f32 v[188:189], v[188:189], v[204:205]
  v_pk_mul_f32 v[190:191], v[190:191], v[206:207]
  v_cvt_pk_bf16_f32 v176, v176, v177
  v_cvt_pk_bf16_f32 v177, v178, v179
  v_cvt_pk_bf16_f32 v178, v180, v181
  v_cvt_pk_bf16_f32 v179, v182, v183
  v_pk_fma_f32 v[192:193], v[160:161], v[160:161], s[44:45]
  v_pk_fma_f32 v[194:195], v[162:163], v[162:163], s[44:45]
  v_pk_fma_f32 v[196:197], v[164:165], v[164:165], s[44:45]
  v_pk_fma_f32 v[198:199], v[166:167], v[166:167], s[44:45]
  v_pk_fma_f32 v[200:201], v[168:169], v[168:169], s[44:45]
  v_pk_fma_f32 v[202:203], v[170:171], v[170:171], s[44:45]
  v_pk_fma_f32 v[204:205], v[172:173], v[172:173], s[44:45]
  v_pk_fma_f32 v[206:207], v[174:175], v[174:175], s[44:45]
  v_pk_mul_f32 v[192:193], v[192:193], v[160:161] neg_lo:[1,0] neg_hi:[1,0]
  v_pk_mul_f32 v[194:195], v[194:195], v[162:163] neg_lo:[1,0] neg_hi:[1,0]
  v_pk_mul_f32 v[196:197], v[196:197], v[164:165] neg_lo:[1,0] neg_hi:[1,0]
  v_pk_mul_f32 v[198:199], v[198:199], v[166:167] neg_lo:[1,0] neg_hi:[1,0]
  v_pk_mul_f32 v[200:201], v[200:201], v[168:169] neg_lo:[1,0] neg_hi:[1,0]
  v_pk_mul_f32 v[202:203], v[202:203], v[170:171] neg_lo:[1,0] neg_hi:[1,0]
  v_pk_mul_f32 v[204:205], v[204:205], v[172:173] neg_lo:[1,0] neg_hi:[1,0]
  v_pk_mul_f32 v[206:207], v[206:207], v[174:175] neg_lo:[1,0] neg_hi:[1,0]
  s_cmp_lt_u32 s28, 4
  s_cbranch_scc1 L_prio_15
  s_setprio 0
L_prio_15:
  s_waitcnt lgkmcnt(12)
  v_mfma_f32_32x32x16_bf16 v[64:79], v[232:235], v[176:179], v[64:79]
  v_exp_f32 v192, v192
  v_exp_f32 v193, v193
  v_cvt_pk_bf16_f32 v184, v184, v185
  v_cvt_pk_bf16_f32 v185, v186, v187
  v_mfma_f32_32x32x16_bf16 v[80:95], v[236:239], v[176:179], v[80:95]
  v_exp_f32 v194, v194
  v_exp_f32 v195, v195
  v_cvt_pk_bf16_f32 v186, v188, v189
  v_cvt_pk_bf16_f32 v187, v190, v191
  v_mfma_f32_32x32x16_bf16 v[96:111], v[240:243], v[176:179], v[96:111]
  v_exp_f32 v196, v196
  v_exp_f32 v197, v197
  v_exp_f32 v198, v198
  v_mfma_f32_32x32x16_bf16 v[64:79], v[244:247], v[184:187], v[64:79]
  v_exp_f32 v199, v199
  v_exp_f32 v200, v200
  v_exp_f32 v201, v201
  v_mfma_f32_32x32x16_bf16 v[80:95], v[248:251], v[184:187], v[80:95]
  v_exp_f32 v202, v202
  v_exp_f32 v203, v203
  v_exp_f32 v204, v204
  v_mfma_f32_32x32x16_bf16 v[96:111], v[252:255], v[184:187], v[96:111]
  v_exp_f32 v205, v205
  v_exp_f32 v206, v206
  v_exp_f32 v207, v207
  s_add_u32 m0, s101, 2048
  s_add_u32 s100, s100, s17
  buffer_load_dwordx4 v11, s[12:15], s100 offen lds
  v_fma_f32 v192, v192, s46, s46
  v_fma_f32 v193, v193, s46, s46
  v_pk_fma_f32 v[194:195], v[194:195], s[46:47], s[46:47]
  v_pk_fma_f32 v[196:197], v[196:197], s[46:47], s[46:47]
  v_pk_fma_f32 v[198:199], v[198:199], s[46:47], s[46:47]
  v_pk_fma_f32 v[200:201], v[200:201], s[46:47], s[46:47]
  v_pk_fma_f32 v[202:203], v[202:203], s[46:47], s[46:47]
  v_pk_fma_f32 v[204:205], v[204:205], s[46:47], s[46:47]
  v_pk_fma_f32 v[206:207], v[206:207], s[46:47], s[46:47]
  s_waitcnt lgkmcnt(0)
  v_mfma_f32_32x32x16_bf16 v[176:191], v[208:211], v[16:19], 0
  v_rcp_f32 v192, v192
  v_rcp_f32 v193, v193
  v_rcp_f32 v194, v194
  v_mfma_f32_32x32x16_bf16 v[176:191], v[212:215], v[20:23], v[176:191]
  v_rcp_f32 v195, v195
  v_rcp_f32 v196, v196
  v_rcp_f32 v197, v197
  v_mfma_f32_32x32x16_bf16 v[176:191], v[216:219], v[24:27], v[176:191]
  v_rcp_f32 v198, v198
  v_rcp_f32 v199, v199
  v_rcp_f32 v200, v200
  v_mfma_f32_32x32x16_bf16 v[176:191], v[220:223], v[28:31], v[176:191]
  v_rcp_f32 v201, v201
  v_rcp_f32 v202, v202
  v_rcp_f32 v203, v203
  v_mfma_f32_32x32x16_bf16 v[176:191], v[224:227], v[32:35], v[176:191]
  v_rcp_f32 v204, v204
  v_rcp_f32 v205, v205
  v_mul_f32 v160, v160, v192
  v_mul_f32 v161, v161, v193
  v_mfma_f32_32x32x16_bf16 v[176:191], v[228:231], v[36:39], v[176:191]
  v_rcp_f32 v206, v206
  v_rcp_f32 v207, v207
  v_mul_f32 v162, v162, v194
  v_mul_f32 v163, v163, v195
  v_mul_f32 v164, v164, v196
  v_mul_f32 v165, v165, v197
  v_pk_mul_f32 v[166:167], v[166:167], v[198:199]
  v_pk_mul_f32 v[168:169], v[168:169], v[200:201]
  v_pk_mul_f32 v[170:171], v[170:171], v[202:203]
  v_pk_mul_f32 v[172:173], v[172:173], v[204:205]
  v_pk_mul_f32 v[174:175], v[174:175], v[206:207]
  v_cvt_pk_bf16_f32 v160, v160, v161
  v_cvt_pk_bf16_f32 v161, v162, v163
  v_cvt_pk_bf16_f32 v162, v164, v165
  v_cvt_pk_bf16_f32 v163, v166, v167
  v_pk_fma_f32 v[192:193], v[176:177], v[176:177], s[44:45]
  v_pk_fma_f32 v[194:195], v[178:179], v[178:179], s[44:45]
  v_pk_fma_f32 v[196:197], v[180:181], v[180:181], s[44:45]
  v_pk_fma_f32 v[198:199], v[182:183], v[182:183], s[44:45]
  v_pk_fma_f32 v[200:201], v[184:185], v[184:185], s[44:45]
  v_pk_fma_f32 v[202:203], v[186:187], v[186:187], s[44:45]
  v_pk_fma_f32 v[204:205], v[188:189], v[188:189], s[44:45]
  v_pk_fma_f32 v[206:207], v[190:191], v[190:191], s[44:45]
  v_pk_mul_f32 v[192:193], v[192:193], v[176:177] neg_lo:[1,0] neg_hi:[1,0]
  v_pk_mul_f32 v[194:195], v[194:195], v[178:179] neg_lo:[1,0] neg_hi:[1,0]
  v_pk_mul_f32 v[196:197], v[196:197], v[180:181] neg_lo:[1,0] neg_hi:[1,0]
  v_pk_mul_f32 v[198:199], v[198:199], v[182:183] neg_lo:[1,0] neg_hi:[1,0]
  v_pk_mul_f32 v[200:201], v[200:201], v[184:185] neg_lo:[1,0] neg_hi:[1,0]
  v_pk_mul_f32 v[202:203], v[202:203], v[186:187] neg_lo:[1,0] neg_hi:[1,0]
  v_pk_mul_f32 v[204:205], v[204:205], v[188:189] neg_lo:[1,0] neg_hi:[1,0]
  v_pk_mul_f32 v[206:207], v[206:207], v[190:191] neg_lo:[1,0] neg_hi:[1,0]
  v_mfma_f32_32x32x16_bf16 v[112:127], v[232:235], v[160:163], v[112:127]
  v_exp_f32 v192, v192
  v_exp_f32 v193, v193
  v_cvt_pk_bf16_f32 v168, v168, v169
  v_cvt_pk_bf16_f32 v169, v170, v171
  v_mfma_f32_32x32x16_bf16 v[128:143], v[236:239], v[160:163], v[128:143]
  v_exp_f32 v194, v194
  v_exp_f32 v195, v195
  v_cvt_pk_bf16_f32 v170, v172, v173
  v_cvt_pk_bf16_f32 v171, v174, v175
  v_mfma_f32_32x32x16_bf16 v[144:159], v[240:243], v[160:163], v[144:159]
  v_exp_f32 v196, v196
  v_exp_f32 v197, v197
  v_exp_f32 v198, v198
  v_mfma_f32_32x32x16_bf16 v[112:127], v[244:247], v[168:171], v[112:127]
  v_exp_f32 v199, v199
  v_exp_f32 v200, v200
  v_exp_f32 v201, v201
  v_mfma_f32_32x32x16_bf16 v[128:143], v[248:251], v[168:171], v[128:143]
  v_exp_f32 v202, v202
  v_exp_f32 v203, v203
  v_exp_f32 v204, v204
  v_mfma_f32_32x32x16_bf16 v[144:159], v[252:255], v[168:171], v[144:159]
  v_exp_f32 v205, v205
  v_exp_f32 v206, v206
  v_exp_f32 v207, v207
  ds_read_b64_tr_b16 v[232:233], v2 offset:18432
  ds_read_b64_tr_b16 v[234:235], v2 offset:19200
  ds_read_b64_tr_b16 v[236:237], v2 offset:18496
  ds_read_b64_tr_b16 v[238:239], v2 offset:19264
  ds_read_b64_tr_b16 v[240:241], v2 offset:18560
  ds_read_b64_tr_b16 v[242:243], v2 offset:19328
  ds_read_b64_tr_b16 v[244:245], v2 offset:21504
  ds_read_b64_tr_b16 v[246:247], v2 offset:22272
  ds_read_b64_tr_b16 v[248:249], v2 offset:21568
  ds_read_b64_tr_b16 v[250:251], v2 offset:22336
  ds_read_b64_tr_b16 v[252:253], v2 offset:21632
  ds_read_b64_tr_b16 v[254:255], v2 offset:22400
  v_pk_fma_f32 v[192:193], v[192:193], s[46:47], s[46:47]
  v_pk_fma_f32 v[194:195], v[194:195], s[46:47], s[46:47]
  v_pk_fma_f32 v[196:197], v[196:197], s[46:47], s[46:47]
  v_pk_fma_f32 v[198:199], v[198:199], s[46:47], s[46:47]
  v_pk_fma_f32 v[200:201], v[200:201], s[46:47], s[46:47]
  v_pk_fma_f32 v[202:203], v[202:203], s[46:47], s[46:47]
  v_pk_fma_f32 v[204:205], v[204:205], s[46:47], s[46:47]
  v_pk_fma_f32 v[206:207], v[206:207], s[46:47], s[46:47]
  v_mfma_f32_32x32x16_bf16 v[160:175], v[208:211], v[40:43], 0
  v_rcp_f32 v192, v192
  v_rcp_f32 v193, v193
  v_rcp_f32 v194, v194
  v_mfma_f32_32x32x16_bf16 v[160:175], v[212:215], v[44:47], v[160:175]
  v_rcp_f32 v195, v195
  v_rcp_f32 v196, v196
  v_rcp_f32 v197, v197
  v_mfma_f32_32x32x16_bf16 v[160:175], v[216:219], v[48:51], v[160:175]
  v_rcp_f32 v198, v198
  v_rcp_f32 v199, v199
  v_rcp_f32 v200, v200
  v_mfma_f32_32x32x16_bf16 v[160:175], v[220:223], v[52:55], v[160:175]
  v_rcp_f32 v201, v201
  v_rcp_f32 v202, v202
  v_rcp_f32 v203, v203
  v_mfma_f32_32x32x16_bf16 v[160:175], v[224:227], v[56:59], v[160:175]
  v_rcp_f32 v204, v204
  v_rcp_f32 v205, v205
  v_mul_f32 v176, v176, v192
  v_mul_f32 v177, v177, v193
  v_mfma_f32_32x32x16_bf16 v[160:175], v[228:231], v[60:63], v[160:175]
  v_rcp_f32 v206, v206
  v_rcp_f32 v207, v207
  v_mul_f32 v178, v178, v194
  v_mul_f32 v179, v179, v195
  ds_read_b64_tr_b16 v[208:209], v1 offset:24576
  ds_read_b64_tr_b16 v[210:211], v1 offset:24832
  ds_read_b64_tr_b16 v[212:213], v1 offset:25600
  ds_read_b64_tr_b16 v[214:215], v1 offset:25856
  ds_read_b64_tr_b16 v[216:217], v1 offset:26624
  ds_read_b64_tr_b16 v[218:219], v1 offset:26880
  ds_read_b64_tr_b16 v[220:221], v1 offset:27648
  ds_read_b64_tr_b16 v[222:223], v1 offset:27904
  ds_read_b64_tr_b16 v[224:225], v1 offset:28672
  ds_read_b64_tr_b16 v[226:227], v1 offset:28928
  ds_read_b64_tr_b16 v[228:229], v1 offset:29696
  ds_read_b64_tr_b16 v[230:231], v1 offset:29952
  v_pk_mul_f32 v[180:181], v[180:181], v[196:197]
  v_pk_mul_f32 v[182:183], v[182:183], v[198:199]
  v_pk_mul_f32 v[184:185], v[184:185], v[200:201]
  v_pk_mul_f32 v[186:187], v[186:187], v[202:203]
  v_pk_mul_f32 v[188:189], v[188:189], v[204:205]
  v_pk_mul_f32 v[190:191], v[190:191], v[206:207]
  v_cvt_pk_bf16_f32 v176, v176, v177
  v_cvt_pk_bf16_f32 v177, v178, v179
  v_cvt_pk_bf16_f32 v178, v180, v181
  v_cvt_pk_bf16_f32 v179, v182, v183
  v_pk_fma_f32 v[192:193], v[160:161], v[160:161], s[44:45]
  v_pk_fma_f32 v[194:195], v[162:163], v[162:163], s[44:45]
  v_pk_fma_f32 v[196:197], v[164:165], v[164:165], s[44:45]
  v_pk_fma_f32 v[198:199], v[166:167], v[166:167], s[44:45]
  v_pk_fma_f32 v[200:201], v[168:169], v[168:169], s[44:45]
  v_pk_fma_f32 v[202:203], v[170:171], v[170:171], s[44:45]
  v_pk_fma_f32 v[204:205], v[172:173], v[172:173], s[44:45]
  v_pk_fma_f32 v[206:207], v[174:175], v[174:175], s[44:45]
  v_pk_mul_f32 v[192:193], v[192:193], v[160:161] neg_lo:[1,0] neg_hi:[1,0]
  v_pk_mul_f32 v[194:195], v[194:195], v[162:163] neg_lo:[1,0] neg_hi:[1,0]
  v_pk_mul_f32 v[196:197], v[196:197], v[164:165] neg_lo:[1,0] neg_hi:[1,0]
  v_pk_mul_f32 v[198:199], v[198:199], v[166:167] neg_lo:[1,0] neg_hi:[1,0]
  v_pk_mul_f32 v[200:201], v[200:201], v[168:169] neg_lo:[1,0] neg_hi:[1,0]
  v_pk_mul_f32 v[202:203], v[202:203], v[170:171] neg_lo:[1,0] neg_hi:[1,0]
  v_pk_mul_f32 v[204:205], v[204:205], v[172:173] neg_lo:[1,0] neg_hi:[1,0]
  v_pk_mul_f32 v[206:207], v[206:207], v[174:175] neg_lo:[1,0] neg_hi:[1,0]
  s_cmp_lt_u32 s28, 4
  s_cbranch_scc1 L_prio_16
  s_setprio 1
L_prio_16:
  s_waitcnt lgkmcnt(12)
  v_mfma_f32_32x32x16_bf16 v[64:79], v[232:235], v[176:179], v[64:79]
  v_exp_f32 v192, v192
  v_exp_f32 v193, v193
  v_cvt_pk_bf16_f32 v184, v184, v185
  v_cvt_pk_bf16_f32 v185, v186, v187
  v_mfma_f32_32x32x16_bf16 v[80:95], v[236:239], v[176:179], v[80:95]
  v_exp_f32 v194, v194
  v_exp_f32 v195, v195
  v_cvt_pk_bf16_f32 v186, v188, v189
  v_cvt_pk_bf16_f32 v187, v190, v191
  v_mfma_f32_32x32x16_bf16 v[96:111], v[240:243], v[176:179], v[96:111]
  v_exp_f32 v196, v196
  v_exp_f32 v197, v197
  v_exp_f32 v198, v198
  v_mfma_f32_32x32x16_bf16 v[64:79], v[244:247], v[184:187], v[64:79]
  v_exp_f32 v199, v199
  v_exp_f32 v200, v200
  v_exp_f32 v201, v201
  v_mfma_f32_32x32x16_bf16 v[80:95], v[248:251], v[184:187], v[80:95]
  v_exp_f32 v202, v202
  v_exp_f32 v203, v203
  v_exp_f32 v204, v204
  v_mfma_f32_32x32x16_bf16 v[96:111], v[252:255], v[184:187], v[96:111]
  v_exp_f32 v205, v205
  v_exp_f32 v206, v206
  v_exp_f32 v207, v207
  v_fma_f32 v192, v192, s46, s46
  v_fma_f32 v193, v193, s46, s46
  v_pk_fma_f32 v[194:195], v[194:195], s[46:47], s[46:47]
  v_pk_fma_f32 v[196:197], v[196:197], s[46:47], s[46:47]
  v_pk_fma_f32 v[198:199], v[198:199], s[46:47], s[46:47]
  v_pk_fma_f32 v[200:201], v[200:201], s[46:47], s[46:47]
  v_pk_fma_f32 v[202:203], v[202:203], s[46:47], s[46:47]
  v_pk_fma_f32 v[204:205], v[204:205], s[46:47], s[46:47]
  v_pk_fma_f32 v[206:207], v[206:207], s[46:47], s[46:47]
  s_waitcnt lgkmcnt(0)
  v_mfma_f32_32x32x16_bf16 v[176:191], v[208:211], v[16:19], 0
  v_rcp_f32 v192, v192
  v_rcp_f32 v193, v193
  v_rcp_f32 v194, v194
  v_mfma_f32_32x32x16_bf16 v[176:191], v[212:215], v[20:23], v[176:191]
  v_rcp_f32 v195, v195
  v_rcp_f32 v196, v196
  v_rcp_f32 v197, v197
  v_mfma_f32_32x32x16_bf16 v[176:191], v[216:219], v[24:27], v[176:191]
  v_rcp_f32 v198, v198
  v_rcp_f32 v199, v199
  v_rcp_f32 v200, v200
  v_mfma_f32_32x32x16_bf16 v[176:191], v[220:223], v[28:31], v[176:191]
  v_rcp_f32 v201, v201
  v_rcp_f32 v202, v202
  v_rcp_f32 v203, v203
  v_mfma_f32_32x32x16_bf16 v[176:191], v[224:227], v[32:35], v[176:191]
  v_rcp_f32 v204, v204
  v_rcp_f32 v205, v205
  v_mul_f32 v160, v160, v192
  v_mul_f32 v161, v161, v193
  v_mfma_f32_32x32x16_bf16 v[176:191], v[228:231], v[36:39], v[176:191]
  v_rcp_f32 v206, v206
  v_rcp_f32 v207, v207
  v_mul_f32 v162, v162, v194
  v_mul_f32 v163, v163, v195
  v_mul_f32 v164, v164, v196
  v_mul_f32 v165, v165, v197
  v_pk_mul_f32 v[166:167], v[166:167], v[198:199]
  v_pk_mul_f32 v[168:169], v[168:169], v[200:201]
  v_pk_mul_f32 v[170:171], v[170:171], v[202:203]
  v_pk_mul_f32 v[172:173], v[172:173], v[204:205]
  v_pk_mul_f32 v[174:175], v[174:175], v[206:207]
  v_cvt_pk_bf16_f32 v160, v160, v161
  v_cvt_pk_bf16_f32 v161, v162, v163
  v_cvt_pk_bf16_f32 v162, v164, v165
  v_cvt_pk_bf16_f32 v163, v166, v167
  v_pk_fma_f32 v[192:193], v[176:177], v[176:177], s[44:45]
  v_pk_fma_f32 v[194:195], v[178:179], v[178:179], s[44:45]
  v_pk_fma_f32 v[196:197], v[180:181], v[180:181], s[44:45]
  v_pk_fma_f32 v[198:199], v[182:183], v[182:183], s[44:45]
  v_pk_fma_f32 v[200:201], v[184:185], v[184:185], s[44:45]
  v_pk_fma_f32 v[202:203], v[186:187], v[186:187], s[44:45]
  v_pk_fma_f32 v[204:205], v[188:189], v[188:189], s[44:45]
  v_pk_fma_f32 v[206:207], v[190:191], v[190:191], s[44:45]
  v_pk_mul_f32 v[192:193], v[192:193], v[176:177] neg_lo:[1,0] neg_hi:[1,0]
  v_pk_mul_f32 v[194:195], v[194:195], v[178:179] neg_lo:[1,0] neg_hi:[1,0]
  v_pk_mul_f32 v[196:197], v[196:197], v[180:181] neg_lo:[1,0] neg_hi:[1,0]
  v_pk_mul_f32 v[198:199], v[198:199], v[182:183] neg_lo:[1,0] neg_hi:[1,0]
  v_pk_mul_f32 v[200:201], v[200:201], v[184:185] neg_lo:[1,0] neg_hi:[1,0]
  v_pk_mul_f32 v[202:203], v[202:203], v[186:187] neg_lo:[1,0] neg_hi:[1,0]
  v_pk_mul_f32 v[204:205], v[204:205], v[188:189] neg_lo:[1,0] neg_hi:[1,0]
  v_pk_mul_f32 v[206:207], v[206:207], v[190:191] neg_lo:[1,0] neg_hi:[1,0]
  v_mfma_f32_32x32x16_bf16 v[112:127], v[232:235], v[160:163], v[112:127]
  v_exp_f32 v192, v192
  v_exp_f32 v193, v193
  v_cvt_pk_bf16_f32 v168, v168, v169
  v_cvt_pk_bf16_f32 v169, v170, v171
  v_mfma_f32_32x32x16_bf16 v[128:143], v[236:239], v[160:163], v[128:143]
  v_exp_f32 v194, v194
  v_exp_f32 v195, v195
  v_cvt_pk_bf16_f32 v170, v172, v173
  v_cvt_pk_bf16_f32 v171, v174, v175
  v_mfma_f32_32x32x16_bf16 v[144:159], v[240:243], v[160:163], v[144:159]
  v_exp_f32 v196, v196
  v_exp_f32 v197, v197
  v_exp_f32 v198, v198
  v_mfma_f32_32x32x16_bf16 v[112:127], v[244:247], v[168:171], v[112:127]
  v_exp_f32 v199, v199
  v_exp_f32 v200, v200
  v_exp_f32 v201, v201
  v_mfma_f32_32x32x16_bf16 v[128:143], v[248:251], v[168:171], v[128:143]
  v_exp_f32 v202, v202
  v_exp_f32 v203, v203
  v_exp_f32 v204, v204
  v_mfma_f32_32x32x16_bf16 v[144:159], v[252:255], v[168:171], v[144:159]
  v_exp_f32 v205, v205
  v_exp_f32 v206, v206
  v_exp_f32 v207, v207
  ds_read_b64_tr_b16 v[232:233], v2 offset:30720
  ds_read_b64_tr_b16 v[234:235], v2 offset:31488
  ds_read_b64_tr_b16 v[236:237], v2 offset:30784
  ds_read_b64_tr_b16 v[238:239], v2 offset:31552
  ds_read_b64_tr_b16 v[240:241], v2 offset:30848
  ds_read_b64_tr_b16 v[242:243], v2 offset:31616
  ds_read_b64_tr_b16 v[244:245], v2 offset:33792
  ds_read_b64_tr_b16 v[246:247], v2 offset:34560
  ds_read_b64_tr_b16 v[248:249], v2 offset:33856
  ds_read_b64_tr_b16 v[250:251], v2 offset:34624
  ds_read_b64_tr_b16 v[252:253], v2 offset:33920
  ds_read_b64_tr_b16 v[254:255], v2 offset:34688
  v_pk_fma_f32 v[192:193], v[192:193], s[46:47], s[46:47]
  v_pk_fma_f32 v[194:195], v[194:195], s[46:47], s[46:47]
  v_pk_fma_f32 v[196:197], v[196:197], s[46:47], s[46:47]
  v_pk_fma_f32 v[198:199], v[198:199], s[46:47], s[46:47]
  v_pk_fma_f32 v[200:201], v[200:201], s[46:47], s[46:47]
  v_pk_fma_f32 v[202:203], v[202:203], s[46:47], s[46:47]
  v_pk_fma_f32 v[204:205], v[204:205], s[46:47], s[46:47]
  v_pk_fma_f32 v[206:207], v[206:207], s[46:47], s[46:47]
  v_mfma_f32_32x32x16_bf16 v[160:175], v[208:211], v[40:43], 0
  v_rcp_f32 v192, v192
  v_rcp_f32 v193, v193
  v_rcp_f32 v194, v194
  v_mfma_f32_32x32x16_bf16 v[160:175], v[212:215], v[44:47], v[160:175]
  v_rcp_f32 v195, v195
  v_rcp_f32 v196, v196
  v_rcp_f32 v197, v197
  v_mfma_f32_32x32x16_bf16 v[160:175], v[216:219], v[48:51], v[160:175]
  v_rcp_f32 v198, v198
  v_rcp_f32 v199, v199
  v_rcp_f32 v200, v200
  v_mfma_f32_32x32x16_bf16 v[160:175], v[220:223], v[52:55], v[160:175]
  v_rcp_f32 v201, v201
  v_rcp_f32 v202, v202
  v_rcp_f32 v203, v203
  v_mfma_f32_32x32x16_bf16 v[160:175], v[224:227], v[56:59], v[160:175]
  v_rcp_f32 v204, v204
  v_rcp_f32 v205, v205
  v_mul_f32 v176, v176, v192
  v_mul_f32 v177, v177, v193
  v_mfma_f32_32x32x16_bf16 v[160:175], v[228:231], v[60:63], v[160:175]
  v_rcp_f32 v206, v206
  v_rcp_f32 v207, v207
  v_mul_f32 v178, v178, v194
  v_mul_f32 v179, v179, v195
  s_waitcnt vmcnt(0)
  s_barrier
  v_add_u32 v1, 73728, v1
  ds_read_b64_tr_b16 v[208:209], v1 offset:24576
  ds_read_b64_tr_b16 v[210:211], v1 offset:24832
  ds_read_b64_tr_b16 v[212:213], v1 offset:25600
  ds_read_b64_tr_b16 v[214:215], v1 offset:25856
  ds_read_b64_tr_b16 v[216:217], v1 offset:26624
  ds_read_b64_tr_b16 v[218:219], v1 offset:26880
  ds_read_b64_tr_b16 v[220:221], v1 offset:27648
  ds_read_b64_tr_b16 v[222:223], v1 offset:27904
  ds_read_b64_tr_b16 v[224:225], v1 offset:28672
  ds_read_b64_tr_b16 v[226:227], v1 offset:28928
  ds_read_b64_tr_b16 v[228:229], v1 offset:29696
  ds_read_b64_tr_b16 v[230:231], v1 offset:29952
  v_pk_mul_f32 v[180:181], v[180:181], v[196:197]
  v_pk_mul_f32 v[182:183], v[182:183], v[198:199]
  v_pk_mul_f32 v[184:185], v[184:185], v[200:201]
  v_pk_mul_f32 v[186:187], v[186:187], v[202:203]
  v_pk_mul_f32 v[188:189], v[188:189], v[204:205]
  v_pk_mul_f32 v[190:191], v[190:191], v[206:207]
  v_cvt_pk_bf16_f32 v176, v176, v177
  v_cvt_pk_bf16_f32 v177, v178, v179
  v_cvt_pk_bf16_f32 v178, v180, v181
  v_cvt_pk_bf16_f32 v179, v182, v183
  v_pk_fma_f32 v[192:193], v[160:161], v[160:161], s[44:45]
  v_pk_fma_f32 v[194:195], v[162:163], v[162:163], s[44:45]
  v_pk_fma_f32 v[196:197], v[164:165], v[164:165], s[44:45]
  v_pk_fma_f32 v[198:199], v[166:167], v[166:167], s[44:45]
  v_pk_fma_f32 v[200:201], v[168:169], v[168:169], s[44:45]
  v_pk_fma_f32 v[202:203], v[170:171], v[170:171], s[44:45]
  v_pk_fma_f32 v[204:205], v[172:173], v[172:173], s[44:45]
  v_pk_fma_f32 v[206:207], v[174:175], v[174:175], s[44:45]
  v_pk_mul_f32 v[192:193], v[192:193], v[160:161] neg_lo:[1,0] neg_hi:[1,0]
  v_pk_mul_f32 v[194:195], v[194:195], v[162:163] neg_lo:[1,0] neg_hi:[1,0]
  v_pk_mul_f32 v[196:197], v[196:197], v[164:165] neg_lo:[1,0] neg_hi:[1,0]
  v_pk_mul_f32 v[198:199], v[198:199], v[166:167] neg_lo:[1,0] neg_hi:[1,0]
  v_pk_mul_f32 v[200:201], v[200:201], v[168:169] neg_lo:[1,0] neg_hi:[1,0]
  v_pk_mul_f32 v[202:203], v[202:203], v[170:171] neg_lo:[1,0] neg_hi:[1,0]
  v_pk_mul_f32 v[204:205], v[204:205], v[172:173] neg_lo:[1,0] neg_hi:[1,0]
  v_pk_mul_f32 v[206:207], v[206:207], v[174:175] neg_lo:[1,0] neg_hi:[1,0]
  s_cmp_lt_u32 s28, 4
  s_cbranch_scc1 L_prio_17
  s_setprio 0
L_prio_17:
  s_waitcnt lgkmcnt(12)
  v_mfma_f32_32x32x16_bf16 v[64:79], v[232:235], v[176:179], v[64:79]
  v_exp_f32 v192, v192
  v_exp_f32 v193, v193
  v_cvt_pk_bf16_f32 v184, v184, v185
  v_cvt_pk_bf16_f32 v185, v186, v187
  v_mfma_f32_32x32x16_bf16 v[80:95], v[236:239], v[176:179], v[80:95]
  v_exp_f32 v194, v194
  v_exp_f32 v195, v195
  v_cvt_pk_bf16_f32 v186, v188, v189
  v_cvt_pk_bf16_f32 v187, v190, v191
  v_mfma_f32_32x32x16_bf16 v[96:111], v[240:243], v[176:179], v[96:111]
  v_exp_f32 v196, v196
  v_exp_f32 v197, v197
  v_exp_f32 v198, v198
  v_mfma_f32_32x32x16_bf16 v[64:79], v[244:247], v[184:187], v[64:79]
  v_exp_f32 v199, v199
  v_exp_f32 v200, v200
  v_exp_f32 v201, v201
  v_mfma_f32_32x32x16_bf16 v[80:95], v[248:251], v[184:187], v[80:95]
  v_exp_f32 v202, v202
  v_exp_f32 v203, v203
  v_exp_f32 v204, v204
  v_mfma_f32_32x32x16_bf16 v[96:111], v[252:255], v[184:187], v[96:111]
  v_exp_f32 v205, v205
  v_exp_f32 v206, v206
  v_exp_f32 v207, v207
  v_fma_f32 v192, v192, s46, s46
  v_fma_f32 v193, v193, s46, s46
  v_pk_fma_f32 v[194:195], v[194:195], s[46:47], s[46:47]
  v_pk_fma_f32 v[196:197], v[196:197], s[46:47], s[46:47]
  v_pk_fma_f32 v[198:199], v[198:199], s[46:47], s[46:47]
  v_pk_fma_f32 v[200:201], v[200:201], s[46:47], s[46:47]
  v_pk_fma_f32 v[202:203], v[202:203], s[46:47], s[46:47]
  v_pk_fma_f32 v[204:205], v[204:205], s[46:47], s[46:47]
  v_pk_fma_f32 v[206:207], v[206:207], s[46:47], s[46:47]
  s_waitcnt lgkmcnt(0)
  v_mfma_f32_32x32x16_bf16 v[176:191], v[208:211], v[16:19], 0
  v_rcp_f32 v192, v192
  v_rcp_f32 v193, v193
  v_rcp_f32 v194, v194
  v_mfma_f32_32x32x16_bf16 v[176:191], v[212:215], v[20:23], v[176:191]
  v_rcp_f32 v195, v195
  v_rcp_f32 v196, v196
  v_rcp_f32 v197, v197
  v_mfma_f32_32x32x16_bf16 v[176:191], v[216:219], v[24:27], v[176:191]
  v_rcp_f32 v198, v198
  v_rcp_f32 v199, v199
  v_rcp_f32 v200, v200
  v_mfma_f32_32x32x16_bf16 v[176:191], v[220:223], v[28:31], v[176:191]
  v_rcp_f32 v201, v201
  v_rcp_f32 v202, v202
  v_rcp_f32 v203, v203
  v_mfma_f32_32x32x16_bf16 v[176:191], v[224:227], v[32:35], v[176:191]
  v_rcp_f32 v204, v204
  v_rcp_f32 v205, v205
  v_mul_f32 v160, v160, v192
  v_mul_f32 v161, v161, v193
  v_mfma_f32_32x32x16_bf16 v[176:191], v[228:231], v[36:39], v[176:191]
  v_rcp_f32 v206, v206
  v_rcp_f32 v207, v207
  v_mul_f32 v162, v162, v194
  v_mul_f32 v163, v163, v195
  v_mul_f32 v164, v164, v196
  v_mul_f32 v165, v165, v197
  v_pk_mul_f32 v[166:167], v[166:167], v[198:199]
  v_pk_mul_f32 v[168:169], v[168:169], v[200:201]
  v_pk_mul_f32 v[170:171], v[170:171], v[202:203]
  v_pk_mul_f32 v[172:173], v[172:173], v[204:205]
  v_pk_mul_f32 v[174:175], v[174:175], v[206:207]
  v_cvt_pk_bf16_f32 v160, v160, v161
  v_cvt_pk_bf16_f32 v161, v162, v163
  v_cvt_pk_bf16_f32 v162, v164, v165
  v_cvt_pk_bf16_f32 v163, v166, v167
  v_pk_fma_f32 v[192:193], v[176:177], v[176:177], s[44:45]
  v_pk_fma_f32 v[194:195], v[178:179], v[178:179], s[44:45]
  v_pk_fma_f32 v[196:197], v[180:181], v[180:181], s[44:45]
  v_pk_fma_f32 v[198:199], v[182:183], v[182:183], s[44:45]
  v_pk_fma_f32 v[200:201], v[184:185], v[184:185], s[44:45]
  v_pk_fma_f32 v[202:203], v[186:187], v[186:187], s[44:45]
  v_pk_fma_f32 v[204:205], v[188:189], v[188:189], s[44:45]
  v_pk_fma_f32 v[206:207], v[190:191], v[190:191], s[44:45]
  v_pk_mul_f32 v[192:193], v[192:193], v[176:177] neg_lo:[1,0] neg_hi:[1,0]
  v_pk_mul_f32 v[194:195], v[194:195], v[178:179] neg_lo:[1,0] neg_hi:[1,0]
  v_pk_mul_f32 v[196:197], v[196:197], v[180:181] neg_lo:[1,0] neg_hi:[1,0]
  v_pk_mul_f32 v[198:199], v[198:199], v[182:183] neg_lo:[1,0] neg_hi:[1,0]
  v_pk_mul_f32 v[200:201], v[200:201], v[184:185] neg_lo:[1,0] neg_hi:[1,0]
  v_pk_mul_f32 v[202:203], v[202:203], v[186:187] neg_lo:[1,0] neg_hi:[1,0]
  v_pk_mul_f32 v[204:205], v[204:205], v[188:189] neg_lo:[1,0] neg_hi:[1,0]
  v_pk_mul_f32 v[206:207], v[206:207], v[190:191] neg_lo:[1,0] neg_hi:[1,0]
  v_mfma_f32_32x32x16_bf16 v[112:127], v[232:235], v[160:163], v[112:127]
  v_exp_f32 v192, v192
  v_exp_f32 v193, v193
  v_cvt_pk_bf16_f32 v168, v168, v169
  v_cvt_pk_bf16_f32 v169, v170, v171
  v_mfma_f32_32x32x16_bf16 v[128:143], v[236:239], v[160:163], v[128:143]
  v_exp_f32 v194, v194
  v_exp_f32 v195, v195
  v_cvt_pk_bf16_f32 v170, v172, v173
  v_cvt_pk_bf16_f32 v171, v174, v175
  v_mfma_f32_32x32x16_bf16 v[144:159], v[240:243], v[160:163], v[144:159]
  v_exp_f32 v196, v196
  v_exp_f32 v197, v197
  v_exp_f32 v198, v198
  v_mfma_f32_32x32x16_bf16 v[112:127], v[244:247], v[168:171], v[112:127]
  v_exp_f32 v199, v199
  v_exp_f32 v200, v200
  v_exp_f32 v201, v201
  v_mfma_f32_32x32x16_bf16 v[128:143], v[248:251], v[168:171], v[128:143]
  v_exp_f32 v202, v202
  v_exp_f32 v203, v203
  v_exp_f32 v204, v204
  v_mfma_f32_32x32x16_bf16 v[144:159], v[252:255], v[168:171], v[144:159]
  v_exp_f32 v205, v205
  v_exp_f32 v206, v206
  v_exp_f32 v207, v207
  v_add_u32 v2, 73728, v2
  ds_read_b64_tr_b16 v[232:233], v2 offset:30720
  ds_read_b64_tr_b16 v[234:235], v2 offset:31488
  ds_read_b64_tr_b16 v[236:237], v2 offset:30784
  ds_read_b64_tr_b16 v[238:239], v2 offset:31552
  ds_read_b64_tr_b16 v[240:241], v2 offset:30848
  ds_read_b64_tr_b16 v[242:243], v2 offset:31616
  ds_read_b64_tr_b16 v[244:245], v2 offset:33792
  ds_read_b64_tr_b16 v[246:247], v2 offset:34560
  ds_read_b64_tr_b16 v[248:249], v2 offset:33856
  ds_read_b64_tr_b16 v[250:251], v2 offset:34624
  ds_read_b64_tr_b16 v[252:253], v2 offset:33920
  ds_read_b64_tr_b16 v[254:255], v2 offset:34688
  v_pk_fma_f32 v[192:193], v[192:193], s[46:47], s[46:47]
  v_pk_fma_f32 v[194:195], v[194:195], s[46:47], s[46:47]
  v_pk_fma_f32 v[196:197], v[196:197], s[46:47], s[46:47]
  v_pk_fma_f32 v[198:199], v[198:199], s[46:47], s[46:47]
  v_pk_fma_f32 v[200:201], v[200:201], s[46:47], s[46:47]
  v_pk_fma_f32 v[202:203], v[202:203], s[46:47], s[46:47]
  v_pk_fma_f32 v[204:205], v[204:205], s[46:47], s[46:47]
  v_pk_fma_f32 v[206:207], v[206:207], s[46:47], s[46:47]
  v_mfma_f32_32x32x16_bf16 v[160:175], v[208:211], v[40:43], 0
  v_rcp_f32 v192, v192
  v_rcp_f32 v193, v193
  v_rcp_f32 v194, v194
  v_mfma_f32_32x32x16_bf16 v[160:175], v[212:215], v[44:47], v[160:175]
  v_rcp_f32 v195, v195
  v_rcp_f32 v196, v196
  v_rcp_f32 v197, v197
  v_mfma_f32_32x32x16_bf16 v[160:175], v[216:219], v[48:51], v[160:175]
  v_rcp_f32 v198, v198
  v_rcp_f32 v199, v199
  v_rcp_f32 v200, v200
  v_mfma_f32_32x32x16_bf16 v[160:175], v[220:223], v[52:55], v[160:175]
  v_rcp_f32 v201, v201
  v_rcp_f32 v202, v202
  v_rcp_f32 v203, v203
  v_mfma_f32_32x32x16_bf16 v[160:175], v[224:227], v[56:59], v[160:175]
  v_rcp_f32 v204, v204
  v_rcp_f32 v205, v205
  v_mul_f32 v176, v176, v192
  v_mul_f32 v177, v177, v193
  v_mfma_f32_32x32x16_bf16 v[160:175], v[228:231], v[60:63], v[160:175]
  v_rcp_f32 v206, v206
  v_rcp_f32 v207, v207
  v_mul_f32 v178, v178, v194
  v_mul_f32 v179, v179, v195
  ds_read_b64_tr_b16 v[208:209], v1 offset:36864
  ds_read_b64_tr_b16 v[210:211], v1 offset:37120
  ds_read_b64_tr_b16 v[212:213], v1 offset:37888
  ds_read_b64_tr_b16 v[214:215], v1 offset:38144
  ds_read_b64_tr_b16 v[216:217], v1 offset:38912
  ds_read_b64_tr_b16 v[218:219], v1 offset:39168
  ds_read_b64_tr_b16 v[220:221], v1 offset:39936
  ds_read_b64_tr_b16 v[222:223], v1 offset:40192
  ds_read_b64_tr_b16 v[224:225], v1 offset:40960
  ds_read_b64_tr_b16 v[226:227], v1 offset:41216
  ds_read_b64_tr_b16 v[228:229], v1 offset:41984
  ds_read_b64_tr_b16 v[230:231], v1 offset:42240
  v_pk_mul_f32 v[180:181], v[180:181], v[196:197]
  v_pk_mul_f32 v[182:183], v[182:183], v[198:199]
  v_pk_mul_f32 v[184:185], v[184:185], v[200:201]
  v_pk_mul_f32 v[186:187], v[186:187], v[202:203]
  v_pk_mul_f32 v[188:189], v[188:189], v[204:205]
  v_pk_mul_f32 v[190:191], v[190:191], v[206:207]
  v_cvt_pk_bf16_f32 v176, v176, v177
  v_cvt_pk_bf16_f32 v177, v178, v179
  v_cvt_pk_bf16_f32 v178, v180, v181
  v_cvt_pk_bf16_f32 v179, v182, v183
  v_pk_fma_f32 v[192:193], v[160:161], v[160:161], s[44:45]
  v_pk_fma_f32 v[194:195], v[162:163], v[162:163], s[44:45]
  v_pk_fma_f32 v[196:197], v[164:165], v[164:165], s[44:45]
  v_pk_fma_f32 v[198:199], v[166:167], v[166:167], s[44:45]
  v_pk_fma_f32 v[200:201], v[168:169], v[168:169], s[44:45]
  v_pk_fma_f32 v[202:203], v[170:171], v[170:171], s[44:45]
  v_pk_fma_f32 v[204:205], v[172:173], v[172:173], s[44:45]
  v_pk_fma_f32 v[206:207], v[174:175], v[174:175], s[44:45]
  v_pk_mul_f32 v[192:193], v[192:193], v[160:161] neg_lo:[1,0] neg_hi:[1,0]
  v_pk_mul_f32 v[194:195], v[194:195], v[162:163] neg_lo:[1,0] neg_hi:[1,0]
  v_pk_mul_f32 v[196:197], v[196:197], v[164:165] neg_lo:[1,0] neg_hi:[1,0]
  v_pk_mul_f32 v[198:199], v[198:199], v[166:167] neg_lo:[1,0] neg_hi:[1,0]
  v_pk_mul_f32 v[200:201], v[200:201], v[168:169] neg_lo:[1,0] neg_hi:[1,0]
  v_pk_mul_f32 v[202:203], v[202:203], v[170:171] neg_lo:[1,0] neg_hi:[1,0]
  v_pk_mul_f32 v[204:205], v[204:205], v[172:173] neg_lo:[1,0] neg_hi:[1,0]
  v_pk_mul_f32 v[206:207], v[206:207], v[174:175] neg_lo:[1,0] neg_hi:[1,0]
  s_cmp_lt_u32 s28, 4
  s_cbranch_scc1 L_prio_18
  s_setprio 1
L_prio_18:
  s_waitcnt lgkmcnt(12)
  v_mfma_f32_32x32x16_bf16 v[64:79], v[232:235], v[176:179], v[64:79]
  v_exp_f32 v192, v192
  v_exp_f32 v193, v193
  v_cvt_pk_bf16_f32 v184, v184, v185
  v_cvt_pk_bf16_f32 v185, v186, v187
  v_mfma_f32_32x32x16_bf16 v[80:95], v[236:239], v[176:179], v[80:95]
  v_exp_f32 v194, v194
  v_exp_f32 v195, v195
  v_cvt_pk_bf16_f32 v186, v188, v189
  v_cvt_pk_bf16_f32 v187, v190, v191
  v_mfma_f32_32x32x16_bf16 v[96:111], v[240:243], v[176:179], v[96:111]
  v_exp_f32 v196, v196
  v_exp_f32 v197, v197
  v_exp_f32 v198, v198
  v_mfma_f32_32x32x16_bf16 v[64:79], v[244:247], v[184:187], v[64:79]
  v_exp_f32 v199, v199
  v_exp_f32 v200, v200
  v_exp_f32 v201, v201
  v_mfma_f32_32x32x16_bf16 v[80:95], v[248:251], v[184:187], v[80:95]
  v_exp_f32 v202, v202
  v_exp_f32 v203, v203
  v_exp_f32 v204, v204
  v_mfma_f32_32x32x16_bf16 v[96:111], v[252:255], v[184:187], v[96:111]
  v_exp_f32 v205, v205
  v_exp_f32 v206, v206
  v_exp_f32 v207, v207
  v_fma_f32 v192, v192, s46, s46
  v_fma_f32 v193, v193, s46, s46
  v_pk_fma_f32 v[194:195], v[194:195], s[46:47], s[46:47]
  v_pk_fma_f32 v[196:197], v[196:197], s[46:47], s[46:47]
  v_pk_fma_f32 v[198:199], v[198:199], s[46:47], s[46:47]
  v_pk_fma_f32 v[200:201], v[200:201], s[46:47], s[46:47]
  v_pk_fma_f32 v[202:203], v[202:203], s[46:47], s[46:47]
  v_pk_fma_f32 v[204:205], v[204:205], s[46:47], s[46:47]
  v_pk_fma_f32 v[206:207], v[206:207], s[46:47], s[46:47]
  s_waitcnt lgkmcnt(0)
  v_mfma_f32_32x32x16_bf16 v[176:191], v[208:211], v[16:19], 0
  v_rcp_f32 v192, v192
  v_rcp_f32 v193, v193
  v_rcp_f32 v194, v194
  v_mfma_f32_32x32x16_bf16 v[176:191], v[212:215], v[20:23], v[176:191]
  v_rcp_f32 v195, v195
  v_rcp_f32 v196, v196
  v_rcp_f32 v197, v197
  v_mfma_f32_32x32x16_bf16 v[176:191], v[216:219], v[24:27], v[176:191]
  v_rcp_f32 v198, v198
  v_rcp_f32 v199, v199
  v_rcp_f32 v200, v200
  v_mfma_f32_32x32x16_bf16 v[176:191], v[220:223], v[28:31], v[176:191]
  v_rcp_f32 v201, v201
  v_rcp_f32 v202, v202
  v_rcp_f32 v203, v203
  v_mfma_f32_32x32x16_bf16 v[176:191], v[224:227], v[32:35], v[176:191]
  v_rcp_f32 v204, v204
  v_rcp_f32 v205, v205
  v_mul_f32 v160, v160, v192
  v_mul_f32 v161, v161, v193
  v_mfma_f32_32x32x16_bf16 v[176:191], v[228:231], v[36:39], v[176:191]
  v_rcp_f32 v206, v206
  v_rcp_f32 v207, v207
  v_mul_f32 v162, v162, v194
  v_mul_f32 v163, v163, v195
  v_mul_f32 v164, v164, v196
  v_mul_f32 v165, v165, v197
  v_pk_mul_f32 v[166:167], v[166:167], v[198:199]
  v_pk_mul_f32 v[168:169], v[168:169], v[200:201]
  v_pk_mul_f32 v[170:171], v[170:171], v[202:203]
  v_pk_mul_f32 v[172:173], v[172:173], v[204:205]
  v_pk_mul_f32 v[174:175], v[174:175], v[206:207]
  v_cvt_pk_bf16_f32 v160, v160, v161
  v_cvt_pk_bf16_f32 v161, v162, v163
  v_cvt_pk_bf16_f32 v162, v164, v165
  v_cvt_pk_bf16_f32 v163, v166, v167
  v_pk_fma_f32 v[192:193], v[176:177], v[176:177], s[44:45]
  v_pk_fma_f32 v[194:195], v[178:179], v[178:179], s[44:45]
  v_pk_fma_f32 v[196:197], v[180:181], v[180:181], s[44:45]
  v_pk_fma_f32 v[198:199], v[182:183], v[182:183], s[44:45]
  v_pk_fma_f32 v[200:201], v[184:185], v[184:185], s[44:45]
  v_pk_fma_f32 v[202:203], v[186:187], v[186:187], s[44:45]
  v_pk_fma_f32 v[204:205], v[188:189], v[188:189], s[44:45]
  v_pk_fma_f32 v[206:207], v[190:191], v[190:191], s[44:45]
  v_pk_mul_f32 v[192:193], v[192:193], v[176:177] neg_lo:[1,0] neg_hi:[1,0]
  v_pk_mul_f32 v[194:195], v[194:195], v[178:179] neg_lo:[1,0] neg_hi:[1,0]
  v_pk_mul_f32 v[196:197], v[196:197], v[180:181] neg_lo:[1,0] neg_hi:[1,0]
  v_pk_mul_f32 v[198:199], v[198:199], v[182:183] neg_lo:[1,0] neg_hi:[1,0]
  v_pk_mul_f32 v[200:201], v[200:201], v[184:185] neg_lo:[1,0] neg_hi:[1,0]
  v_pk_mul_f32 v[202:203], v[202:203], v[186:187] neg_lo:[1,0] neg_hi:[1,0]
  v_pk_mul_f32 v[204:205], v[204:205], v[188:189] neg_lo:[1,0] neg_hi:[1,0]
  v_pk_mul_f32 v[206:207], v[206:207], v[190:191] neg_lo:[1,0] neg_hi:[1,0]
  v_mfma_f32_32x32x16_bf16 v[112:127], v[232:235], v[160:163], v[112:127]
  v_exp_f32 v192, v192
  v_exp_f32 v193, v193
  v_cvt_pk_bf16_f32 v168, v168, v169
  v_cvt_pk_bf16_f32 v169, v170, v171
  v_mfma_f32_32x32x16_bf16 v[128:143], v[236:239], v[160:163], v[128:143]
  v_exp_f32 v194, v194
  v_exp_f32 v195, v195
  v_cvt_pk_bf16_f32 v170, v172, v173
  v_cvt_pk_bf16_f32 v171, v174, v175
  v_mfma_f32_32x32x16_bf16 v[144:159], v[240:243], v[160:163], v[144:159]
  v_exp_f32 v196, v196
  v_exp_f32 v197, v197
  v_exp_f32 v198, v198
  v_mfma_f32_32x32x16_bf16 v[112:127], v[244:247], v[168:171], v[112:127]
  v_exp_f32 v199, v199
  v_exp_f32 v200, v200
  v_exp_f32 v201, v201
  v_mfma_f32_32x32x16_bf16 v[128:143], v[248:251], v[168:171], v[128:143]
  v_exp_f32 v202, v202
  v_exp_f32 v203, v203
  v_exp_f32 v204, v204
  v_mfma_f32_32x32x16_bf16 v[144:159], v[252:255], v[168:171], v[144:159]
  v_exp_f32 v205, v205
  v_exp_f32 v206, v206
  v_exp_f32 v207, v207
  ds_read_b64_tr_b16 v[232:233], v2 offset:43008
  ds_read_b64_tr_b16 v[234:235], v2 offset:43776
  ds_read_b64_tr_b16 v[236:237], v2 offset:43072
  ds_read_b64_tr_b16 v[238:239], v2 offset:43840
  ds_read_b64_tr_b16 v[240:241], v2 offset:43136
  ds_read_b64_tr_b16 v[242:243], v2 offset:43904
  ds_read_b64_tr_b16 v[244:245], v2 offset:46080
  ds_read_b64_tr_b16 v[246:247], v2 offset:46848
  ds_read_b64_tr_b16 v[248:249], v2 offset:46144
  ds_read_b64_tr_b16 v[250:251], v2 offset:46912
  ds_read_b64_tr_b16 v[252:253], v2 offset:46208
  ds_read_b64_tr_b16 v[254:255], v2 offset:46976
  v_pk_fma_f32 v[192:193], v[192:193], s[46:47], s[46:47]
  v_pk_fma_f32 v[194:195], v[194:195], s[46:47], s[46:47]
  v_pk_fma_f32 v[196:197], v[196:197], s[46:47], s[46:47]
  v_pk_fma_f32 v[198:199], v[198:199], s[46:47], s[46:47]
  v_pk_fma_f32 v[200:201], v[200:201], s[46:47], s[46:47]
  v_pk_fma_f32 v[202:203], v[202:203], s[46:47], s[46:47]
  v_pk_fma_f32 v[204:205], v[204:205], s[46:47], s[46:47]
  v_pk_fma_f32 v[206:207], v[206:207], s[46:47], s[46:47]
  v_mfma_f32_32x32x16_bf16 v[160:175], v[208:211], v[40:43], 0
  v_rcp_f32 v192, v192
  v_rcp_f32 v193, v193
  v_rcp_f32 v194, v194
  v_mfma_f32_32x32x16_bf16 v[160:175], v[212:215], v[44:47], v[160:175]
  v_rcp_f32 v195, v195
  v_rcp_f32 v196, v196
  v_rcp_f32 v197, v197
  v_mfma_f32_32x32x16_bf16 v[160:175], v[216:219], v[48:51], v[160:175]
  v_rcp_f32 v198, v198
  v_rcp_f32 v199, v199
  v_rcp_f32 v200, v200
  v_mfma_f32_32x32x16_bf16 v[160:175], v[220:223], v[52:55], v[160:175]
  v_rcp_f32 v201, v201
  v_rcp_f32 v202, v202
  v_rcp_f32 v203, v203
  v_mfma_f32_32x32x16_bf16 v[160:175], v[224:227], v[56:59], v[160:175]
  v_rcp_f32 v204, v204
  v_rcp_f32 v205, v205
  v_mul_f32 v176, v176, v192
  v_mul_f32 v177, v177, v193
  v_mfma_f32_32x32x16_bf16 v[160:175], v[228:231], v[60:63], v[160:175]
  v_rcp_f32 v206, v206
  v_rcp_f32 v207, v207
  v_mul_f32 v178, v178, v194
  v_mul_f32 v179, v179, v195
  ds_read_b64_tr_b16 v[208:209], v1 offset:49152
  ds_read_b64_tr_b16 v[210:211], v1 offset:49408
  ds_read_b64_tr_b16 v[212:213], v1 offset:50176
  ds_read_b64_tr_b16 v[214:215], v1 offset:50432
  ds_read_b64_tr_b16 v[216:217], v1 offset:51200
  ds_read_b64_tr_b16 v[218:219], v1 offset:51456
  ds_read_b64_tr_b16 v[220:221], v1 offset:52224
  ds_read_b64_tr_b16 v[222:223], v1 offset:52480
  ds_read_b64_tr_b16 v[224:225], v1 offset:53248
  ds_read_b64_tr_b16 v[226:227], v1 offset:53504
  ds_read_b64_tr_b16 v[228:229], v1 offset:54272
  ds_read_b64_tr_b16 v[230:231], v1 offset:54528
  v_pk_mul_f32 v[180:181], v[180:181], v[196:197]
  v_pk_mul_f32 v[182:183], v[182:183], v[198:199]
  v_pk_mul_f32 v[184:185], v[184:185], v[200:201]
  v_pk_mul_f32 v[186:187], v[186:187], v[202:203]
  v_pk_mul_f32 v[188:189], v[188:189], v[204:205]
  v_pk_mul_f32 v[190:191], v[190:191], v[206:207]
  v_cvt_pk_bf16_f32 v176, v176, v177
  v_cvt_pk_bf16_f32 v177, v178, v179
  v_cvt_pk_bf16_f32 v178, v180, v181
  v_cvt_pk_bf16_f32 v179, v182, v183
  v_pk_fma_f32 v[192:193], v[160:161], v[160:161], s[44:45]
  v_pk_fma_f32 v[194:195], v[162:163], v[162:163], s[44:45]
  v_pk_fma_f32 v[196:197], v[164:165], v[164:165], s[44:45]
  v_pk_fma_f32 v[198:199], v[166:167], v[166:167], s[44:45]
  v_pk_fma_f32 v[200:201], v[168:169], v[168:169], s[44:45]
  v_pk_fma_f32 v[202:203], v[170:171], v[170:171], s[44:45]
  v_pk_fma_f32 v[204:205], v[172:173], v[172:173], s[44:45]
  v_pk_fma_f32 v[206:207], v[174:175], v[174:175], s[44:45]
  v_pk_mul_f32 v[192:193], v[192:193], v[160:161] neg_lo:[1,0] neg_hi:[1,0]
  v_pk_mul_f32 v[194:195], v[194:195], v[162:163] neg_lo:[1,0] neg_hi:[1,0]
  v_pk_mul_f32 v[196:197], v[196:197], v[164:165] neg_lo:[1,0] neg_hi:[1,0]
  v_pk_mul_f32 v[198:199], v[198:199], v[166:167] neg_lo:[1,0] neg_hi:[1,0]
  v_pk_mul_f32 v[200:201], v[200:201], v[168:169] neg_lo:[1,0] neg_hi:[1,0]
  v_pk_mul_f32 v[202:203], v[202:203], v[170:171] neg_lo:[1,0] neg_hi:[1,0]
  v_pk_mul_f32 v[204:205], v[204:205], v[172:173] neg_lo:[1,0] neg_hi:[1,0]
  v_pk_mul_f32 v[206:207], v[206:207], v[174:175] neg_lo:[1,0] neg_hi:[1,0]
  s_cmp_lt_u32 s28, 4
  s_cbranch_scc1 L_prio_19
  s_setprio 0
L_prio_19:
  s_waitcnt lgkmcnt(12)
  v_mfma_f32_32x32x16_bf16 v[64:79], v[232:235], v[176:179], v[64:79]
  v_exp_f32 v192, v192
  v_exp_f32 v193, v193
  v_cvt_pk_bf16_f32 v184, v184, v185
  v_cvt_pk_bf16_f32 v185, v186, v187
  v_mfma_f32_32x32x16_bf16 v[80:95], v[236:239], v[176:179], v[80:95]
  v_exp_f32 v194, v194
  v_exp_f32 v195, v195
  v_cvt_pk_bf16_f32 v186, v188, v189
  v_cvt_pk_bf16_f32 v187, v190, v191
  v_mfma_f32_32x32x16_bf16 v[96:111], v[240:243], v[176:179], v[96:111]
  v_exp_f32 v196, v196
  v_exp_f32 v197, v197
  v_exp_f32 v198, v198
  v_mfma_f32_32x32x16_bf16 v[64:79], v[244:247], v[184:187], v[64:79]
  v_exp_f32 v199, v199
  v_exp_f32 v200, v200
  v_exp_f32 v201, v201
  v_mfma_f32_32x32x16_bf16 v[80:95], v[248:251], v[184:187], v[80:95]
  v_exp_f32 v202, v202
  v_exp_f32 v203, v203
  v_exp_f32 v204, v204
  v_mfma_f32_32x32x16_bf16 v[96:111], v[252:255], v[184:187], v[96:111]
  v_exp_f32 v205, v205
  v_exp_f32 v206, v206
  v_exp_f32 v207, v207
  v_fma_f32 v192, v192, s46, s46
  v_fma_f32 v193, v193, s46, s46
  v_pk_fma_f32 v[194:195], v[194:195], s[46:47], s[46:47]
  v_pk_fma_f32 v[196:197], v[196:197], s[46:47], s[46:47]
  v_pk_fma_f32 v[198:199], v[198:199], s[46:47], s[46:47]
  v_pk_fma_f32 v[200:201], v[200:201], s[46:47], s[46:47]
  v_pk_fma_f32 v[202:203], v[202:203], s[46:47], s[46:47]
  v_pk_fma_f32 v[204:205], v[204:205], s[46:47], s[46:47]
  v_pk_fma_f32 v[206:207], v[206:207], s[46:47], s[46:47]
  s_waitcnt lgkmcnt(0)
  v_mfma_f32_32x32x16_bf16 v[176:191], v[208:211], v[16:19], 0
  v_rcp_f32 v192, v192
  v_rcp_f32 v193, v193
  v_rcp_f32 v194, v194
  v_mfma_f32_32x32x16_bf16 v[176:191], v[212:215], v[20:23], v[176:191]
  v_rcp_f32 v195, v195
  v_rcp_f32 v196, v196
  v_rcp_f32 v197, v197
  v_mfma_f32_32x32x16_bf16 v[176:191], v[216:219], v[24:27], v[176:191]
  v_rcp_f32 v198, v198
  v_rcp_f32 v199, v199
  v_rcp_f32 v200, v200
  v_mfma_f32_32x32x16_bf16 v[176:191], v[220:223], v[28:31], v[176:191]
  v_rcp_f32 v201, v201
  v_rcp_f32 v202, v202
  v_rcp_f32 v203, v203
  v_mfma_f32_32x32x16_bf16 v[176:191], v[224:227], v[32:35], v[176:191]
  v_rcp_f32 v204, v204
  v_rcp_f32 v205, v205
  v_mul_f32 v160, v160, v192
  v_mul_f32 v161, v161, v193
  v_mfma_f32_32x32x16_bf16 v[176:191], v[228:231], v[36:39], v[176:191]
  v_rcp_f32 v206, v206
  v_rcp_f32 v207, v207
  v_mul_f32 v162, v162, v194
  v_mul_f32 v163, v163, v195
  v_mul_f32 v164, v164, v196
  v_mul_f32 v165, v165, v197
  v_pk_mul_f32 v[166:167], v[166:167], v[198:199]
  v_pk_mul_f32 v[168:169], v[168:169], v[200:201]
  v_pk_mul_f32 v[170:171], v[170:171], v[202:203]
  v_pk_mul_f32 v[172:173], v[172:173], v[204:205]
  v_pk_mul_f32 v[174:175], v[174:175], v[206:207]
  v_cvt_pk_bf16_f32 v160, v160, v161
  v_cvt_pk_bf16_f32 v161, v162, v163
  v_cvt_pk_bf16_f32 v162, v164, v165
  v_cvt_pk_bf16_f32 v163, v166, v167
  v_pk_fma_f32 v[192:193], v[176:177], v[176:177], s[44:45]
  v_pk_fma_f32 v[194:195], v[178:179], v[178:179], s[44:45]
  v_pk_fma_f32 v[196:197], v[180:181], v[180:181], s[44:45]
  v_pk_fma_f32 v[198:199], v[182:183], v[182:183], s[44:45]
  v_pk_fma_f32 v[200:201], v[184:185], v[184:185], s[44:45]
  v_pk_fma_f32 v[202:203], v[186:187], v[186:187], s[44:45]
  v_pk_fma_f32 v[204:205], v[188:189], v[188:189], s[44:45]
  v_pk_fma_f32 v[206:207], v[190:191], v[190:191], s[44:45]
  v_pk_mul_f32 v[192:193], v[192:193], v[176:177] neg_lo:[1,0] neg_hi:[1,0]
  v_pk_mul_f32 v[194:195], v[194:195], v[178:179] neg_lo:[1,0] neg_hi:[1,0]
  v_pk_mul_f32 v[196:197], v[196:197], v[180:181] neg_lo:[1,0] neg_hi:[1,0]
  v_pk_mul_f32 v[198:199], v[198:199], v[182:183] neg_lo:[1,0] neg_hi:[1,0]
  v_pk_mul_f32 v[200:201], v[200:201], v[184:185] neg_lo:[1,0] neg_hi:[1,0]
  v_pk_mul_f32 v[202:203], v[202:203], v[186:187] neg_lo:[1,0] neg_hi:[1,0]
  v_pk_mul_f32 v[204:205], v[204:205], v[188:189] neg_lo:[1,0] neg_hi:[1,0]
  v_pk_mul_f32 v[206:207], v[206:207], v[190:191] neg_lo:[1,0] neg_hi:[1,0]
  v_mfma_f32_32x32x16_bf16 v[112:127], v[232:235], v[160:163], v[112:127]
  v_exp_f32 v192, v192
  v_exp_f32 v193, v193
  v_cvt_pk_bf16_f32 v168, v168, v169
  v_cvt_pk_bf16_f32 v169, v170, v171
  v_mfma_f32_32x32x16_bf16 v[128:143], v[236:239], v[160:163], v[128:143]
  v_exp_f32 v194, v194
  v_exp_f32 v195, v195
  v_cvt_pk_bf16_f32 v170, v172, v173
  v_cvt_pk_bf16_f32 v171, v174, v175
  v_mfma_f32_32x32x16_bf16 v[144:159], v[240:243], v[160:163], v[144:159]
  v_exp_f32 v196, v196
  v_exp_f32 v197, v197
  v_exp_f32 v198, v198
  v_mfma_f32_32x32x16_bf16 v[112:127], v[244:247], v[168:171], v[112:127]
  v_exp_f32 v199, v199
  v_exp_f32 v200, v200
  v_exp_f32 v201, v201
  v_mfma_f32_32x32x16_bf16 v[128:143], v[248:251], v[168:171], v[128:143]
  v_exp_f32 v202, v202
  v_exp_f32 v203, v203
  v_exp_f32 v204, v204
  v_mfma_f32_32x32x16_bf16 v[144:159], v[252:255], v[168:171], v[144:159]
  v_exp_f32 v205, v205
  v_exp_f32 v206, v206
  v_exp_f32 v207, v207
  ds_read_b64_tr_b16 v[232:233], v2 offset:55296
  ds_read_b64_tr_b16 v[234:235], v2 offset:56064
  ds_read_b64_tr_b16 v[236:237], v2 offset:55360
  ds_read_b64_tr_b16 v[238:239], v2 offset:56128
  ds_read_b64_tr_b16 v[240:241], v2 offset:55424
  ds_read_b64_tr_b16 v[242:243], v2 offset:56192
  ds_read_b64_tr_b16 v[244:245], v2 offset:58368
  ds_read_b64_tr_b16 v[246:247], v2 offset:59136
  ds_read_b64_tr_b16 v[248:249], v2 offset:58432
  ds_read_b64_tr_b16 v[250:251], v2 offset:59200
  ds_read_b64_tr_b16 v[252:253], v2 offset:58496
  ds_read_b64_tr_b16 v[254:255], v2 offset:59264
  v_pk_fma_f32 v[192:193], v[192:193], s[46:47], s[46:47]
  v_pk_fma_f32 v[194:195], v[194:195], s[46:47], s[46:47]
  v_pk_fma_f32 v[196:197], v[196:197], s[46:47], s[46:47]
  v_pk_fma_f32 v[198:199], v[198:199], s[46:47], s[46:47]
  v_pk_fma_f32 v[200:201], v[200:201], s[46:47], s[46:47]
  v_pk_fma_f32 v[202:203], v[202:203], s[46:47], s[46:47]
  v_pk_fma_f32 v[204:205], v[204:205], s[46:47], s[46:47]
  v_pk_fma_f32 v[206:207], v[206:207], s[46:47], s[46:47]
  v_mfma_f32_32x32x16_bf16 v[160:175], v[208:211], v[40:43], 0
  v_rcp_f32 v192, v192
  v_rcp_f32 v193, v193
  v_rcp_f32 v194, v194
  v_mfma_f32_32x32x16_bf16 v[160:175], v[212:215], v[44:47], v[160:175]
  v_rcp_f32 v195, v195
  v_rcp_f32 v196, v196
  v_rcp_f32 v197, v197
  v_mfma_f32_32x32x16_bf16 v[160:175], v[216:219], v[48:51], v[160:175]
  v_rcp_f32 v198, v198
  v_rcp_f32 v199, v199
  v_rcp_f32 v200, v200
  v_mfma_f32_32x32x16_bf16 v[160:175], v[220:223], v[52:55], v[160:175]
  v_rcp_f32 v201, v201
  v_rcp_f32 v202, v202
  v_rcp_f32 v203, v203
  v_mfma_f32_32x32x16_bf16 v[160:175], v[224:227], v[56:59], v[160:175]
  v_rcp_f32 v204, v204
  v_rcp_f32 v205, v205
  v_mul_f32 v176, v176, v192
  v_mul_f32 v177, v177, v193
  v_mfma_f32_32x32x16_bf16 v[160:175], v[228:231], v[60:63], v[160:175]
  v_rcp_f32 v206, v206
  v_rcp_f32 v207, v207
  v_mul_f32 v178, v178, v194
  v_mul_f32 v179, v179, v195
  v_subrev_u32 v1, 12288, v1
  ds_read_b64_tr_b16 v[208:209], v1 offset:0
  ds_read_b64_tr_b16 v[210:211], v1 offset:256
  ds_read_b64_tr_b16 v[212:213], v1 offset:1024
  ds_read_b64_tr_b16 v[214:215], v1 offset:1280
  ds_read_b64_tr_b16 v[216:217], v1 offset:2048
  ds_read_b64_tr_b16 v[218:219], v1 offset:2304
  ds_read_b64_tr_b16 v[220:221], v1 offset:3072
  ds_read_b64_tr_b16 v[222:223], v1 offset:3328
  ds_read_b64_tr_b16 v[224:225], v1 offset:4096
  ds_read_b64_tr_b16 v[226:227], v1 offset:4352
  ds_read_b64_tr_b16 v[228:229], v1 offset:5120
  ds_read_b64_tr_b16 v[230:231], v1 offset:5376
  v_pk_mul_f32 v[180:181], v[180:181], v[196:197]
  v_pk_mul_f32 v[182:183], v[182:183], v[198:199]
  v_pk_mul_f32 v[184:185], v[184:185], v[200:201]
  v_pk_mul_f32 v[186:187], v[186:187], v[202:203]
  v_pk_mul_f32 v[188:189], v[188:189], v[204:205]
  v_pk_mul_f32 v[190:191], v[190:191], v[206:207]
  v_cvt_pk_bf16_f32 v176, v176, v177
  v_cvt_pk_bf16_f32 v177, v178, v179
  v_cvt_pk_bf16_f32 v178, v180, v181
  v_cvt_pk_bf16_f32 v179, v182, v183
  v_pk_fma_f32 v[192:193], v[160:161], v[160:161], s[44:45]
  v_pk_fma_f32 v[194:195], v[162:163], v[162:163], s[44:45]
  v_pk_fma_f32 v[196:197], v[164:165], v[164:165], s[44:45]
  v_pk_fma_f32 v[198:199], v[166:167], v[166:167], s[44:45]
  v_pk_fma_f32 v[200:201], v[168:169], v[168:169], s[44:45]
  v_pk_fma_f32 v[202:203], v[170:171], v[170:171], s[44:45]
  v_pk_fma_f32 v[204:205], v[172:173], v[172:173], s[44:45]
  v_pk_fma_f32 v[206:207], v[174:175], v[174:175], s[44:45]
  v_pk_mul_f32 v[192:193], v[192:193], v[160:161] neg_lo:[1,0] neg_hi:[1,0]
  v_pk_mul_f32 v[194:195], v[194:195], v[162:163] neg_lo:[1,0] neg_hi:[1,0]
  v_pk_mul_f32 v[196:197], v[196:197], v[164:165] neg_lo:[1,0] neg_hi:[1,0]
  v_pk_mul_f32 v[198:199], v[198:199], v[166:167] neg_lo:[1,0] neg_hi:[1,0]
  v_pk_mul_f32 v[200:201], v[200:201], v[168:169] neg_lo:[1,0] neg_hi:[1,0]
  v_pk_mul_f32 v[202:203], v[202:203], v[170:171] neg_lo:[1,0] neg_hi:[1,0]
  v_pk_mul_f32 v[204:205], v[204:205], v[172:173] neg_lo:[1,0] neg_hi:[1,0]
  v_pk_mul_f32 v[206:207], v[206:207], v[174:175] neg_lo:[1,0] neg_hi:[1,0]
  s_cmp_lt_u32 s28, 4
  s_cbranch_scc1 L_prio_20
  s_setprio 1
L_prio_20:
  s_waitcnt lgkmcnt(12)
  v_mfma_f32_32x32x16_bf16 v[64:79], v[232:235], v[176:179], v[64:79]
  v_exp_f32 v192, v192
  v_exp_f32 v193, v193
  v_cvt_pk_bf16_f32 v184, v184, v185
  v_cvt_pk_bf16_f32 v185, v186, v187
  v_mfma_f32_32x32x16_bf16 v[80:95], v[236:239], v[176:179], v[80:95]
  v_exp_f32 v194, v194
  v_exp_f32 v195, v195
  v_cvt_pk_bf16_f32 v186, v188, v189
  v_cvt_pk_bf16_f32 v187, v190, v191
  v_mfma_f32_32x32x16_bf16 v[96:111], v[240:243], v[176:179], v[96:111]
  v_exp_f32 v196, v196
  v_exp_f32 v197, v197
  v_exp_f32 v198, v198
  v_mfma_f32_32x32x16_bf16 v[64:79], v[244:247], v[184:187], v[64:79]
  v_exp_f32 v199, v199
  v_exp_f32 v200, v200
  v_exp_f32 v201, v201
  v_mfma_f32_32x32x16_bf16 v[80:95], v[248:251], v[184:187], v[80:95]
  v_exp_f32 v202, v202
  v_exp_f32 v203, v203
  v_exp_f32 v204, v204
  v_mfma_f32_32x32x16_bf16 v[96:111], v[252:255], v[184:187], v[96:111]
  v_exp_f32 v205, v205
  v_exp_f32 v206, v206
  v_exp_f32 v207, v207
  v_fma_f32 v192, v192, s46, s46
  v_fma_f32 v193, v193, s46, s46
  v_pk_fma_f32 v[194:195], v[194:195], s[46:47], s[46:47]
  v_pk_fma_f32 v[196:197], v[196:197], s[46:47], s[46:47]
  v_pk_fma_f32 v[198:199], v[198:199], s[46:47], s[46:47]
  v_pk_fma_f32 v[200:201], v[200:201], s[46:47], s[46:47]
  v_pk_fma_f32 v[202:203], v[202:203], s[46:47], s[46:47]
  v_pk_fma_f32 v[204:205], v[204:205], s[46:47], s[46:47]
  v_pk_fma_f32 v[206:207], v[206:207], s[46:47], s[46:47]
  s_waitcnt lgkmcnt(0)
  v_mfma_f32_32x32x16_bf16 v[176:191], v[208:211], v[16:19], 0
  v_rcp_f32 v192, v192
  v_rcp_f32 v193, v193
  v_rcp_f32 v194, v194
  v_mfma_f32_32x32x16_bf16 v[176:191], v[212:215], v[20:23], v[176:191]
  v_rcp_f32 v195, v195
  v_rcp_f32 v196, v196
  v_rcp_f32 v197, v197
  v_mfma_f32_32x32x16_bf16 v[176:191], v[216:219], v[24:27], v[176:191]
  v_rcp_f32 v198, v198
  v_rcp_f32 v199, v199
  v_rcp_f32 v200, v200
  v_mfma_f32_32x32x16_bf16 v[176:191], v[220:223], v[28:31], v[176:191]
  v_rcp_f32 v201, v201
  v_rcp_f32 v202, v202
  v_rcp_f32 v203, v203
  v_mfma_f32_32x32x16_bf16 v[176:191], v[224:227], v[32:35], v[176:191]
  v_rcp_f32 v204, v204
  v_rcp_f32 v205, v205
  v_mul_f32 v160, v160, v192
  v_mul_f32 v161, v161, v193
  v_mfma_f32_32x32x16_bf16 v[176:191], v[228:231], v[36:39], v[176:191]
  v_rcp_f32 v206, v206
  v_rcp_f32 v207, v207
  v_mul_f32 v162, v162, v194
  v_mul_f32 v163, v163, v195
  v_mul_f32 v164, v164, v196
  v_mul_f32 v165, v165, v197
  v_pk_mul_f32 v[166:167], v[166:167], v[198:199]
  v_pk_mul_f32 v[168:169], v[168:169], v[200:201]
  v_pk_mul_f32 v[170:171], v[170:171], v[202:203]
  v_pk_mul_f32 v[172:173], v[172:173], v[204:205]
  v_pk_mul_f32 v[174:175], v[174:175], v[206:207]
  v_cvt_pk_bf16_f32 v160, v160, v161
  v_cvt_pk_bf16_f32 v161, v162, v163
  v_cvt_pk_bf16_f32 v162, v164, v165
  v_cvt_pk_bf16_f32 v163, v166, v167
  v_pk_fma_f32 v[192:193], v[176:177], v[176:177], s[44:45]
  v_pk_fma_f32 v[194:195], v[178:179], v[178:179], s[44:45]
  v_pk_fma_f32 v[196:197], v[180:181], v[180:181], s[44:45]
  v_pk_fma_f32 v[198:199], v[182:183], v[182:183], s[44:45]
  v_pk_fma_f32 v[200:201], v[184:185], v[184:185], s[44:45]
  v_pk_fma_f32 v[202:203], v[186:187], v[186:187], s[44:45]
  v_pk_fma_f32 v[204:205], v[188:189], v[188:189], s[44:45]
  v_pk_fma_f32 v[206:207], v[190:191], v[190:191], s[44:45]
  v_pk_mul_f32 v[192:193], v[192:193], v[176:177] neg_lo:[1,0] neg_hi:[1,0]
  v_pk_mul_f32 v[194:195], v[194:195], v[178:179] neg_lo:[1,0] neg_hi:[1,0]
  v_pk_mul_f32 v[196:197], v[196:197], v[180:181] neg_lo:[1,0] neg_hi:[1,0]
  v_pk_mul_f32 v[198:199], v[198:199], v[182:183] neg_lo:[1,0] neg_hi:[1,0]
  v_pk_mul_f32 v[200:201], v[200:201], v[184:185] neg_lo:[1,0] neg_hi:[1,0]
  v_pk_mul_f32 v[202:203], v[202:203], v[186:187] neg_lo:[1,0] neg_hi:[1,0]
  v_pk_mul_f32 v[204:205], v[204:205], v[188:189] neg_lo:[1,0] neg_hi:[1,0]
  v_pk_mul_f32 v[206:207], v[206:207], v[190:191] neg_lo:[1,0] neg_hi:[1,0]
  v_mfma_f32_32x32x16_bf16 v[112:127], v[232:235], v[160:163], v[112:127]
  v_exp_f32 v192, v192
  v_exp_f32 v193, v193
  v_cvt_pk_bf16_f32 v168, v168, v169
  v_cvt_pk_bf16_f32 v169, v170, v171
  v_mfma_f32_32x32x16_bf16 v[128:143], v[236:239], v[160:163], v[128:143]
  v_exp_f32 v194, v194
  v_exp_f32 v195, v195
  v_cvt_pk_bf16_f32 v170, v172, v173
  v_cvt_pk_bf16_f32 v171, v174, v175
  v_mfma_f32_32x32x16_bf16 v[144:159], v[240:243], v[160:163], v[144:159]
  v_exp_f32 v196, v196
  v_exp_f32 v197, v197
  v_exp_f32 v198, v198
  v_mfma_f32_32x32x16_bf16 v[112:127], v[244:247], v[168:171], v[112:127]
  v_exp_f32 v199, v199
  v_exp_f32 v200, v200
  v_exp_f32 v201, v201
  v_mfma_f32_32x32x16_bf16 v[128:143], v[248:251], v[168:171], v[128:143]
  v_exp_f32 v202, v202
  v_exp_f32 v203, v203
  v_exp_f32 v204, v204
  v_mfma_f32_32x32x16_bf16 v[144:159], v[252:255], v[168:171], v[144:159]
  v_exp_f32 v205, v205
  v_exp_f32 v206, v206
  v_exp_f32 v207, v207
  v_subrev_u32 v2, 12288, v2
  ds_read_b64_tr_b16 v[232:233], v2 offset:6144
  ds_read_b64_tr_b16 v[234:235], v2 offset:6912
  ds_read_b64_tr_b16 v[236:237], v2 offset:6208
  ds_read_b64_tr_b16 v[238:239], v2 offset:6976
  ds_read_b64_tr_b16 v[240:241], v2 offset:6272
  ds_read_b64_tr_b16 v[242:243], v2 offset:7040
  ds_read_b64_tr_b16 v[244:245], v2 offset:9216
  ds_read_b64_tr_b16 v[246:247], v2 offset:9984
  ds_read_b64_tr_b16 v[248:249], v2 offset:9280
  ds_read_b64_tr_b16 v[250:251], v2 offset:10048
  ds_read_b64_tr_b16 v[252:253], v2 offset:9344
  ds_read_b64_tr_b16 v[254:255], v2 offset:10112
  v_pk_fma_f32 v[192:193], v[192:193], s[46:47], s[46:47]
  v_pk_fma_f32 v[194:195], v[194:195], s[46:47], s[46:47]
  v_pk_fma_f32 v[196:197], v[196:197], s[46:47], s[46:47]
  v_pk_fma_f32 v[198:199], v[198:199], s[46:47], s[46:47]
  v_pk_fma_f32 v[200:201], v[200:201], s[46:47], s[46:47]
  v_pk_fma_f32 v[202:203], v[202:203], s[46:47], s[46:47]
  v_pk_fma_f32 v[204:205], v[204:205], s[46:47], s[46:47]
  v_pk_fma_f32 v[206:207], v[206:207], s[46:47], s[46:47]
  v_mfma_f32_32x32x16_bf16 v[160:175], v[208:211], v[40:43], 0
  v_rcp_f32 v192, v192
  v_rcp_f32 v193, v193
  v_rcp_f32 v194, v194
  v_mfma_f32_32x32x16_bf16 v[160:175], v[212:215], v[44:47], v[160:175]
  v_rcp_f32 v195, v195
  v_rcp_f32 v196, v196
  v_rcp_f32 v197, v197
  v_mfma_f32_32x32x16_bf16 v[160:175], v[216:219], v[48:51], v[160:175]
  v_rcp_f32 v198, v198
  v_rcp_f32 v199, v199
  v_rcp_f32 v200, v200
  v_mfma_f32_32x32x16_bf16 v[160:175], v[220:223], v[52:55], v[160:175]
  v_rcp_f32 v201, v201
  v_rcp_f32 v202, v202
  v_rcp_f32 v203, v203
  v_mfma_f32_32x32x16_bf16 v[160:175], v[224:227], v[56:59], v[160:175]
  v_rcp_f32 v204, v204
  v_rcp_f32 v205, v205
  v_mul_f32 v176, v176, v192
  v_mul_f32 v177, v177, v193
  v_mfma_f32_32x32x16_bf16 v[160:175], v[228:231], v[60:63], v[160:175]
  v_rcp_f32 v206, v206
  v_rcp_f32 v207, v207
  v_mul_f32 v178, v178, v194
  v_mul_f32 v179, v179, v195
  ds_read_b64_tr_b16 v[208:209], v1 offset:12288
  ds_read_b64_tr_b16 v[210:211], v1 offset:12544
  ds_read_b64_tr_b16 v[212:213], v1 offset:13312
  ds_read_b64_tr_b16 v[214:215], v1 offset:13568
  ds_read_b64_tr_b16 v[216:217], v1 offset:14336
  ds_read_b64_tr_b16 v[218:219], v1 offset:14592
  ds_read_b64_tr_b16 v[220:221], v1 offset:15360
  ds_read_b64_tr_b16 v[222:223], v1 offset:15616
  ds_read_b64_tr_b16 v[224:225], v1 offset:16384
  ds_read_b64_tr_b16 v[226:227], v1 offset:16640
  ds_read_b64_tr_b16 v[228:229], v1 offset:17408
  ds_read_b64_tr_b16 v[230:231], v1 offset:17664
  v_pk_mul_f32 v[180:181], v[180:181], v[196:197]
  v_pk_mul_f32 v[182:183], v[182:183], v[198:199]
  v_pk_mul_f32 v[184:185], v[184:185], v[200:201]
  v_pk_mul_f32 v[186:187], v[186:187], v[202:203]
  v_pk_mul_f32 v[188:189], v[188:189], v[204:205]
  v_pk_mul_f32 v[190:191], v[190:191], v[206:207]
  v_cvt_pk_bf16_f32 v176, v176, v177
  v_cvt_pk_bf16_f32 v177, v178, v179
  v_cvt_pk_bf16_f32 v178, v180, v181
  v_cvt_pk_bf16_f32 v179, v182, v183
  v_pk_fma_f32 v[192:193], v[160:161], v[160:161], s[44:45]
  v_pk_fma_f32 v[194:195], v[162:163], v[162:163], s[44:45]
  v_pk_fma_f32 v[196:197], v[164:165], v[164:165], s[44:45]
  v_pk_fma_f32 v[198:199], v[166:167], v[166:167], s[44:45]
  v_pk_fma_f32 v[200:201], v[168:169], v[168:169], s[44:45]
  v_pk_fma_f32 v[202:203], v[170:171], v[170:171], s[44:45]
  v_pk_fma_f32 v[204:205], v[172:173], v[172:173], s[44:45]
  v_pk_fma_f32 v[206:207], v[174:175], v[174:175], s[44:45]
  v_pk_mul_f32 v[192:193], v[192:193], v[160:161] neg_lo:[1,0] neg_hi:[1,0]
  v_pk_mul_f32 v[194:195], v[194:195], v[162:163] neg_lo:[1,0] neg_hi:[1,0]
  v_pk_mul_f32 v[196:197], v[196:197], v[164:165] neg_lo:[1,0] neg_hi:[1,0]
  v_pk_mul_f32 v[198:199], v[198:199], v[166:167] neg_lo:[1,0] neg_hi:[1,0]
  v_pk_mul_f32 v[200:201], v[200:201], v[168:169] neg_lo:[1,0] neg_hi:[1,0]
  v_pk_mul_f32 v[202:203], v[202:203], v[170:171] neg_lo:[1,0] neg_hi:[1,0]
  v_pk_mul_f32 v[204:205], v[204:205], v[172:173] neg_lo:[1,0] neg_hi:[1,0]
  v_pk_mul_f32 v[206:207], v[206:207], v[174:175] neg_lo:[1,0] neg_hi:[1,0]
  s_cmp_lt_u32 s28, 4
  s_cbranch_scc1 L_prio_21
  s_setprio 0
L_prio_21:
  s_waitcnt lgkmcnt(12)
  v_mfma_f32_32x32x16_bf16 v[64:79], v[232:235], v[176:179], v[64:79]
  v_exp_f32 v192, v192
  v_exp_f32 v193, v193
  v_cvt_pk_bf16_f32 v184, v184, v185
  v_cvt_pk_bf16_f32 v185, v186, v187
  v_mfma_f32_32x32x16_bf16 v[80:95], v[236:239], v[176:179], v[80:95]
  v_exp_f32 v194, v194
  v_exp_f32 v195, v195
  v_cvt_pk_bf16_f32 v186, v188, v189
  v_cvt_pk_bf16_f32 v187, v190, v191
  v_mfma_f32_32x32x16_bf16 v[96:111], v[240:243], v[176:179], v[96:111]
  v_exp_f32 v196, v196
  v_exp_f32 v197, v197
  v_exp_f32 v198, v198
  v_mfma_f32_32x32x16_bf16 v[64:79], v[244:247], v[184:187], v[64:79]
  v_exp_f32 v199, v199
  v_exp_f32 v200, v200
  v_exp_f32 v201, v201
  v_mfma_f32_32x32x16_bf16 v[80:95], v[248:251], v[184:187], v[80:95]
  v_exp_f32 v202, v202
  v_exp_f32 v203, v203
  v_exp_f32 v204, v204
  v_mfma_f32_32x32x16_bf16 v[96:111], v[252:255], v[184:187], v[96:111]
  v_exp_f32 v205, v205
  v_exp_f32 v206, v206
  v_exp_f32 v207, v207
  v_fma_f32 v192, v192, s46, s46
  v_fma_f32 v193, v193, s46, s46
  v_pk_fma_f32 v[194:195], v[194:195], s[46:47], s[46:47]
  v_pk_fma_f32 v[196:197], v[196:197], s[46:47], s[46:47]
  v_pk_fma_f32 v[198:199], v[198:199], s[46:47], s[46:47]
  v_pk_fma_f32 v[200:201], v[200:201], s[46:47], s[46:47]
  v_pk_fma_f32 v[202:203], v[202:203], s[46:47], s[46:47]
  v_pk_fma_f32 v[204:205], v[204:205], s[46:47], s[46:47]
  v_pk_fma_f32 v[206:207], v[206:207], s[46:47], s[46:47]
  s_waitcnt lgkmcnt(0)
  v_mfma_f32_32x32x16_bf16 v[176:191], v[208:211], v[16:19], 0
  v_rcp_f32 v192, v192
  v_rcp_f32 v193, v193
  v_rcp_f32 v194, v194
  v_mfma_f32_32x32x16_bf16 v[176:191], v[212:215], v[20:23], v[176:191]
  v_rcp_f32 v195, v195
  v_rcp_f32 v196, v196
  v_rcp_f32 v197, v197
  v_mfma_f32_32x32x16_bf16 v[176:191], v[216:219], v[24:27], v[176:191]
  v_rcp_f32 v198, v198
  v_rcp_f32 v199, v199
  v_rcp_f32 v200, v200
  v_mfma_f32_32x32x16_bf16 v[176:191], v[220:223], v[28:31], v[176:191]
  v_rcp_f32 v201, v201
  v_rcp_f32 v202, v202
  v_rcp_f32 v203, v203
  v_mfma_f32_32x32x16_bf16 v[176:191], v[224:227], v[32:35], v[176:191]
  v_rcp_f32 v204, v204
  v_rcp_f32 v205, v205
  v_mul_f32 v160, v160, v192
  v_mul_f32 v161, v161, v193
  v_mfma_f32_32x32x16_bf16 v[176:191], v[228:231], v[36:39], v[176:191]
  v_rcp_f32 v206, v206
  v_rcp_f32 v207, v207
  v_mul_f32 v162, v162, v194
  v_mul_f32 v163, v163, v195
  v_mul_f32 v164, v164, v196
  v_mul_f32 v165, v165, v197
  v_pk_mul_f32 v[166:167], v[166:167], v[198:199]
  v_pk_mul_f32 v[168:169], v[168:169], v[200:201]
  v_pk_mul_f32 v[170:171], v[170:171], v[202:203]
  v_pk_mul_f32 v[172:173], v[172:173], v[204:205]
  v_pk_mul_f32 v[174:175], v[174:175], v[206:207]
  v_cvt_pk_bf16_f32 v160, v160, v161
  v_cvt_pk_bf16_f32 v161, v162, v163
  v_cvt_pk_bf16_f32 v162, v164, v165
  v_cvt_pk_bf16_f32 v163, v166, v167
  v_pk_fma_f32 v[192:193], v[176:177], v[176:177], s[44:45]
  v_pk_fma_f32 v[194:195], v[178:179], v[178:179], s[44:45]
  v_pk_fma_f32 v[196:197], v[180:181], v[180:181], s[44:45]
  v_pk_fma_f32 v[198:199], v[182:183], v[182:183], s[44:45]
  v_pk_fma_f32 v[200:201], v[184:185], v[184:185], s[44:45]
  v_pk_fma_f32 v[202:203], v[186:187], v[186:187], s[44:45]
  v_pk_fma_f32 v[204:205], v[188:189], v[188:189], s[44:45]
  v_pk_fma_f32 v[206:207], v[190:191], v[190:191], s[44:45]
  v_pk_mul_f32 v[192:193], v[192:193], v[176:177] neg_lo:[1,0] neg_hi:[1,0]
  v_pk_mul_f32 v[194:195], v[194:195], v[178:179] neg_lo:[1,0] neg_hi:[1,0]
  v_pk_mul_f32 v[196:197], v[196:197], v[180:181] neg_lo:[1,0] neg_hi:[1,0]
  v_pk_mul_f32 v[198:199], v[198:199], v[182:183] neg_lo:[1,0] neg_hi:[1,0]
  v_pk_mul_f32 v[200:201], v[200:201], v[184:185] neg_lo:[1,0] neg_hi:[1,0]
  v_pk_mul_f32 v[202:203], v[202:203], v[186:187] neg_lo:[1,0] neg_hi:[1,0]
  v_pk_mul_f32 v[204:205], v[204:205], v[188:189] neg_lo:[1,0] neg_hi:[1,0]
  v_pk_mul_f32 v[206:207], v[206:207], v[190:191] neg_lo:[1,0] neg_hi:[1,0]
  v_mfma_f32_32x32x16_bf16 v[112:127], v[232:235], v[160:163], v[112:127]
  v_exp_f32 v192, v192
  v_exp_f32 v193, v193
  v_cvt_pk_bf16_f32 v168, v168, v169
  v_cvt_pk_bf16_f32 v169, v170, v171
  v_mfma_f32_32x32x16_bf16 v[128:143], v[236:239], v[160:163], v[128:143]
  v_exp_f32 v194, v194
  v_exp_f32 v195, v195
  v_cvt_pk_bf16_f32 v170, v172, v173
  v_cvt_pk_bf16_f32 v171, v174, v175
  v_mfma_f32_32x32x16_bf16 v[144:159], v[240:243], v[160:163], v[144:159]
  v_exp_f32 v196, v196
  v_exp_f32 v197, v197
  v_exp_f32 v198, v198
  v_mfma_f32_32x32x16_bf16 v[112:127], v[244:247], v[168:171], v[112:127]
  v_exp_f32 v199, v199
  v_exp_f32 v200, v200
  v_exp_f32 v201, v201
  v_mfma_f32_32x32x16_bf16 v[128:143], v[248:251], v[168:171], v[128:143]
  v_exp_f32 v202, v202
  v_exp_f32 v203, v203
  v_exp_f32 v204, v204
  v_mfma_f32_32x32x16_bf16 v[144:159], v[252:255], v[168:171], v[144:159]
  v_exp_f32 v205, v205
  v_exp_f32 v206, v206
  v_exp_f32 v207, v207
  ds_read_b64_tr_b16 v[232:233], v2 offset:18432
  ds_read_b64_tr_b16 v[234:235], v2 offset:19200
  ds_read_b64_tr_b16 v[236:237], v2 offset:18496
  ds_read_b64_tr_b16 v[238:239], v2 offset:19264
  ds_read_b64_tr_b16 v[240:241], v2 offset:18560
  ds_read_b64_tr_b16 v[242:243], v2 offset:19328
  ds_read_b64_tr_b16 v[244:245], v2 offset:21504
  ds_read_b64_tr_b16 v[246:247], v2 offset:22272
  ds_read_b64_tr_b16 v[248:249], v2 offset:21568
  ds_read_b64_tr_b16 v[250:251], v2 offset:22336
  ds_read_b64_tr_b16 v[252:253], v2 offset:21632
  ds_read_b64_tr_b16 v[254:255], v2 offset:22400
  v_pk_fma_f32 v[192:193], v[192:193], s[46:47], s[46:47]
  v_pk_fma_f32 v[194:195], v[194:195], s[46:47], s[46:47]
  v_pk_fma_f32 v[196:197], v[196:197], s[46:47], s[46:47]
  v_pk_fma_f32 v[198:199], v[198:199], s[46:47], s[46:47]
  v_pk_fma_f32 v[200:201], v[200:201], s[46:47], s[46:47]
  v_pk_fma_f32 v[202:203], v[202:203], s[46:47], s[46:47]
  v_pk_fma_f32 v[204:205], v[204:205], s[46:47], s[46:47]
  v_pk_fma_f32 v[206:207], v[206:207], s[46:47], s[46:47]
  v_mfma_f32_32x32x16_bf16 v[160:175], v[208:211], v[40:43], 0
  v_rcp_f32 v192, v192
  v_rcp_f32 v193, v193
  v_rcp_f32 v194, v194
  v_mfma_f32_32x32x16_bf16 v[160:175], v[212:215], v[44:47], v[160:175]
  v_rcp_f32 v195, v195
  v_rcp_f32 v196, v196
  v_rcp_f32 v197, v197
  v_mfma_f32_32x32x16_bf16 v[160:175], v[216:219], v[48:51], v[160:175]
  v_rcp_f32 v198, v198
  v_rcp_f32 v199, v199
  v_rcp_f32 v200, v200
  v_mfma_f32_32x32x16_bf16 v[160:175], v[220:223], v[52:55], v[160:175]
  v_rcp_f32 v201, v201
  v_rcp_f32 v202, v202
  v_rcp_f32 v203, v203
  v_mfma_f32_32x32x16_bf16 v[160:175], v[224:227], v[56:59], v[160:175]
  v_rcp_f32 v204, v204
  v_rcp_f32 v205, v205
  v_mul_f32 v176, v176, v192
  v_mul_f32 v177, v177, v193
  v_mfma_f32_32x32x16_bf16 v[160:175], v[228:231], v[60:63], v[160:175]
  v_rcp_f32 v206, v206
  v_rcp_f32 v207, v207
  v_mul_f32 v178, v178, v194
  v_mul_f32 v179, v179, v195
  ds_read_b64_tr_b16 v[208:209], v1 offset:24576
  ds_read_b64_tr_b16 v[210:211], v1 offset:24832
  ds_read_b64_tr_b16 v[212:213], v1 offset:25600
  ds_read_b64_tr_b16 v[214:215], v1 offset:25856
  ds_read_b64_tr_b16 v[216:217], v1 offset:26624
  ds_read_b64_tr_b16 v[218:219], v1 offset:26880
  ds_read_b64_tr_b16 v[220:221], v1 offset:27648
  ds_read_b64_tr_b16 v[222:223], v1 offset:27904
  ds_read_b64_tr_b16 v[224:225], v1 offset:28672
  ds_read_b64_tr_b16 v[226:227], v1 offset:28928
  ds_read_b64_tr_b16 v[228:229], v1 offset:29696
  ds_read_b64_tr_b16 v[230:231], v1 offset:29952
  v_pk_mul_f32 v[180:181], v[180:181], v[196:197]
  v_pk_mul_f32 v[182:183], v[182:183], v[198:199]
  v_pk_mul_f32 v[184:185], v[184:185], v[200:201]
  v_pk_mul_f32 v[186:187], v[186:187], v[202:203]
  v_pk_mul_f32 v[188:189], v[188:189], v[204:205]
  v_pk_mul_f32 v[190:191], v[190:191], v[206:207]
  v_cvt_pk_bf16_f32 v176, v176, v177
  v_cvt_pk_bf16_f32 v177, v178, v179
  v_cvt_pk_bf16_f32 v178, v180, v181
  v_cvt_pk_bf16_f32 v179, v182, v183
  v_pk_fma_f32 v[192:193], v[160:161], v[160:161], s[44:45]
  v_pk_fma_f32 v[194:195], v[162:163], v[162:163], s[44:45]
  v_pk_fma_f32 v[196:197], v[164:165], v[164:165], s[44:45]
  v_pk_fma_f32 v[198:199], v[166:167], v[166:167], s[44:45]
  v_pk_fma_f32 v[200:201], v[168:169], v[168:169], s[44:45]
  v_pk_fma_f32 v[202:203], v[170:171], v[170:171], s[44:45]
  v_pk_fma_f32 v[204:205], v[172:173], v[172:173], s[44:45]
  v_pk_fma_f32 v[206:207], v[174:175], v[174:175], s[44:45]
  v_pk_mul_f32 v[192:193], v[192:193], v[160:161] neg_lo:[1,0] neg_hi:[1,0]
  v_pk_mul_f32 v[194:195], v[194:195], v[162:163] neg_lo:[1,0] neg_hi:[1,0]
  v_pk_mul_f32 v[196:197], v[196:197], v[164:165] neg_lo:[1,0] neg_hi:[1,0]
  v_pk_mul_f32 v[198:199], v[198:199], v[166:167] neg_lo:[1,0] neg_hi:[1,0]
  v_pk_mul_f32 v[200:201], v[200:201], v[168:169] neg_lo:[1,0] neg_hi:[1,0]
  v_pk_mul_f32 v[202:203], v[202:203], v[170:171] neg_lo:[1,0] neg_hi:[1,0]
  v_pk_mul_f32 v[204:205], v[204:205], v[172:173] neg_lo:[1,0] neg_hi:[1,0]
  v_pk_mul_f32 v[206:207], v[206:207], v[174:175] neg_lo:[1,0] neg_hi:[1,0]
  s_cmp_lt_u32 s28, 4
  s_cbranch_scc1 L_prio_22
  s_setprio 1
L_prio_22:
  s_waitcnt lgkmcnt(12)
  v_mfma_f32_32x32x16_bf16 v[64:79], v[232:235], v[176:179], v[64:79]
  v_exp_f32 v192, v192
  v_exp_f32 v193, v193
  v_cvt_pk_bf16_f32 v184, v184, v185
  v_cvt_pk_bf16_f32 v185, v186, v187
  v_mfma_f32_32x32x16_bf16 v[80:95], v[236:239], v[176:179], v[80:95]
  v_exp_f32 v194, v194
  v_exp_f32 v195, v195
  v_cvt_pk_bf16_f32 v186, v188, v189
  v_cvt_pk_bf16_f32 v187, v190, v191
  v_mfma_f32_32x32x16_bf16 v[96:111], v[240:243], v[176:179], v[96:111]
  v_exp_f32 v196, v196
  v_exp_f32 v197, v197
  v_exp_f32 v198, v198
  v_mfma_f32_32x32x16_bf16 v[64:79], v[244:247], v[184:187], v[64:79]
  v_exp_f32 v199, v199
  v_exp_f32 v200, v200
  v_exp_f32 v201, v201
  v_mfma_f32_32x32x16_bf16 v[80:95], v[248:251], v[184:187], v[80:95]
  v_exp_f32 v202, v202
  v_exp_f32 v203, v203
  v_exp_f32 v204, v204
  v_mfma_f32_32x32x16_bf16 v[96:111], v[252:255], v[184:187], v[96:111]
  v_exp_f32 v205, v205
  v_exp_f32 v206, v206
  v_exp_f32 v207, v207
  v_fma_f32 v192, v192, s46, s46
  v_fma_f32 v193, v193, s46, s46
  v_pk_fma_f32 v[194:195], v[194:195], s[46:47], s[46:47]
  v_pk_fma_f32 v[196:197], v[196:197], s[46:47], s[46:47]
  v_pk_fma_f32 v[198:199], v[198:199], s[46:47], s[46:47]
  v_pk_fma_f32 v[200:201], v[200:201], s[46:47], s[46:47]
  v_pk_fma_f32 v[202:203], v[202:203], s[46:47], s[46:47]
  v_pk_fma_f32 v[204:205], v[204:205], s[46:47], s[46:47]
  v_pk_fma_f32 v[206:207], v[206:207], s[46:47], s[46:47]
  s_waitcnt lgkmcnt(0)
  v_mfma_f32_32x32x16_bf16 v[176:191], v[208:211], v[16:19], 0
  v_rcp_f32 v192, v192
  v_rcp_f32 v193, v193
  v_rcp_f32 v194, v194
  v_mfma_f32_32x32x16_bf16 v[176:191], v[212:215], v[20:23], v[176:191]
  v_rcp_f32 v195, v195
  v_rcp_f32 v196, v196
  v_rcp_f32 v197, v197
  v_mfma_f32_32x32x16_bf16 v[176:191], v[216:219], v[24:27], v[176:191]
  v_rcp_f32 v198, v198
  v_rcp_f32 v199, v199
  v_rcp_f32 v200, v200
  v_mfma_f32_32x32x16_bf16 v[176:191], v[220:223], v[28:31], v[176:191]
  v_rcp_f32 v201, v201
  v_rcp_f32 v202, v202
  v_rcp_f32 v203, v203
  v_mfma_f32_32x32x16_bf16 v[176:191], v[224:227], v[32:35], v[176:191]
  v_rcp_f32 v204, v204
  v_rcp_f32 v205, v205
  v_mul_f32 v160, v160, v192
  v_mul_f32 v161, v161, v193
  v_mfma_f32_32x32x16_bf16 v[176:191], v[228:231], v[36:39], v[176:191]
  v_rcp_f32 v206, v206
  v_rcp_f32 v207, v207
  v_mul_f32 v162, v162, v194
  v_mul_f32 v163, v163, v195
  v_mul_f32 v164, v164, v196
  v_mul_f32 v165, v165, v197
  v_pk_mul_f32 v[166:167], v[166:167], v[198:199]
  v_pk_mul_f32 v[168:169], v[168:169], v[200:201]
  v_pk_mul_f32 v[170:171], v[170:171], v[202:203]
  v_pk_mul_f32 v[172:173], v[172:173], v[204:205]
  v_pk_mul_f32 v[174:175], v[174:175], v[206:207]
  v_cvt_pk_bf16_f32 v160, v160, v161
  v_cvt_pk_bf16_f32 v161, v162, v163
  v_cvt_pk_bf16_f32 v162, v164, v165
  v_cvt_pk_bf16_f32 v163, v166, v167
  v_pk_fma_f32 v[192:193], v[176:177], v[176:177], s[44:45]
  v_pk_fma_f32 v[194:195], v[178:179], v[178:179], s[44:45]
  v_pk_fma_f32 v[196:197], v[180:181], v[180:181], s[44:45]
  v_pk_fma_f32 v[198:199], v[182:183], v[182:183], s[44:45]
  v_pk_fma_f32 v[200:201], v[184:185], v[184:185], s[44:45]
  v_pk_fma_f32 v[202:203], v[186:187], v[186:187], s[44:45]
  v_pk_fma_f32 v[204:205], v[188:189], v[188:189], s[44:45]
  v_pk_fma_f32 v[206:207], v[190:191], v[190:191], s[44:45]
  v_pk_mul_f32 v[192:193], v[192:193], v[176:177] neg_lo:[1,0] neg_hi:[1,0]
  v_pk_mul_f32 v[194:195], v[194:195], v[178:179] neg_lo:[1,0] neg_hi:[1,0]
  v_pk_mul_f32 v[196:197], v[196:197], v[180:181] neg_lo:[1,0] neg_hi:[1,0]
  v_pk_mul_f32 v[198:199], v[198:199], v[182:183] neg_lo:[1,0] neg_hi:[1,0]
  v_pk_mul_f32 v[200:201], v[200:201], v[184:185] neg_lo:[1,0] neg_hi:[1,0]
  v_pk_mul_f32 v[202:203], v[202:203], v[186:187] neg_lo:[1,0] neg_hi:[1,0]
  v_pk_mul_f32 v[204:205], v[204:205], v[188:189] neg_lo:[1,0] neg_hi:[1,0]
  v_pk_mul_f32 v[206:207], v[206:207], v[190:191] neg_lo:[1,0] neg_hi:[1,0]
  v_mfma_f32_32x32x16_bf16 v[112:127], v[232:235], v[160:163], v[112:127]
  v_exp_f32 v192, v192
  v_exp_f32 v193, v193
  v_cvt_pk_bf16_f32 v168, v168, v169
  v_cvt_pk_bf16_f32 v169, v170, v171
  v_mfma_f32_32x32x16_bf16 v[128:143], v[236:239], v[160:163], v[128:143]
  v_exp_f32 v194, v194
  v_exp_f32 v195, v195
  v_cvt_pk_bf16_f32 v170, v172, v173
  v_cvt_pk_bf16_f32 v171, v174, v175
  v_mfma_f32_32x32x16_bf16 v[144:159], v[240:243], v[160:163], v[144:159]
  v_exp_f32 v196, v196
  v_exp_f32 v197, v197
  v_exp_f32 v198, v198
  v_mfma_f32_32x32x16_bf16 v[112:127], v[244:247], v[168:171], v[112:127]
  v_exp_f32 v199, v199
  v_exp_f32 v200, v200
  v_exp_f32 v201, v201
  v_mfma_f32_32x32x16_bf16 v[128:143], v[248:251], v[168:171], v[128:143]
  v_exp_f32 v202, v202
  v_exp_f32 v203, v203
  v_exp_f32 v204, v204
  v_mfma_f32_32x32x16_bf16 v[144:159], v[252:255], v[168:171], v[144:159]
  v_exp_f32 v205, v205
  v_exp_f32 v206, v206
  v_exp_f32 v207, v207
  ds_read_b64_tr_b16 v[232:233], v2 offset:30720
  ds_read_b64_tr_b16 v[234:235], v2 offset:31488
  ds_read_b64_tr_b16 v[236:237], v2 offset:30784
  ds_read_b64_tr_b16 v[238:239], v2 offset:31552
  ds_read_b64_tr_b16 v[240:241], v2 offset:30848
  ds_read_b64_tr_b16 v[242:243], v2 offset:31616
  ds_read_b64_tr_b16 v[244:245], v2 offset:33792
  ds_read_b64_tr_b16 v[246:247], v2 offset:34560
  ds_read_b64_tr_b16 v[248:249], v2 offset:33856
  ds_read_b64_tr_b16 v[250:251], v2 offset:34624
  ds_read_b64_tr_b16 v[252:253], v2 offset:33920
  ds_read_b64_tr_b16 v[254:255], v2 offset:34688
  v_pk_fma_f32 v[192:193], v[192:193], s[46:47], s[46:47]
  v_pk_fma_f32 v[194:195], v[194:195], s[46:47], s[46:47]
  v_pk_fma_f32 v[196:197], v[196:197], s[46:47], s[46:47]
  v_pk_fma_f32 v[198:199], v[198:199], s[46:47], s[46:47]
  v_pk_fma_f32 v[200:201], v[200:201], s[46:47], s[46:47]
  v_pk_fma_f32 v[202:203], v[202:203], s[46:47], s[46:47]
  v_pk_fma_f32 v[204:205], v[204:205], s[46:47], s[46:47]
  v_pk_fma_f32 v[206:207], v[206:207], s[46:47], s[46:47]
  v_mfma_f32_32x32x16_bf16 v[160:175], v[208:211], v[40:43], 0
  v_rcp_f32 v192, v192
  v_rcp_f32 v193, v193
  v_rcp_f32 v194, v194
  v_mfma_f32_32x32x16_bf16 v[160:175], v[212:215], v[44:47], v[160:175]
  v_rcp_f32 v195, v195
  v_rcp_f32 v196, v196
  v_rcp_f32 v197, v197
  v_mfma_f32_32x32x16_bf16 v[160:175], v[216:219], v[48:51], v[160:175]
  v_rcp_f32 v198, v198
  v_rcp_f32 v199, v199
  v_rcp_f32 v200, v200
  v_mfma_f32_32x32x16_bf16 v[160:175], v[220:223], v[52:55], v[160:175]
  v_rcp_f32 v201, v201
  v_rcp_f32 v202, v202
  v_rcp_f32 v203, v203
  v_mfma_f32_32x32x16_bf16 v[160:175], v[224:227], v[56:59], v[160:175]
  v_rcp_f32 v204, v204
  v_rcp_f32 v205, v205
  v_mul_f32 v176, v176, v192
  v_mul_f32 v177, v177, v193
  v_mfma_f32_32x32x16_bf16 v[160:175], v[228:231], v[60:63], v[160:175]
  v_rcp_f32 v206, v206
  v_rcp_f32 v207, v207
  v_mul_f32 v178, v178, v194
  v_mul_f32 v179, v179, v195
  v_subrev_u32 v1, 73728, v1
  ds_read_b64_tr_b16 v[208:209], v1 offset:0
  ds_read_b64_tr_b16 v[210:211], v1 offset:256
  ds_read_b64_tr_b16 v[212:213], v1 offset:1024
  ds_read_b64_tr_b16 v[214:215], v1 offset:1280
  ds_read_b64_tr_b16 v[216:217], v1 offset:2048
  ds_read_b64_tr_b16 v[218:219], v1 offset:2304
  ds_read_b64_tr_b16 v[220:221], v1 offset:3072
  ds_read_b64_tr_b16 v[222:223], v1 offset:3328
  ds_read_b64_tr_b16 v[224:225], v1 offset:4096
  ds_read_b64_tr_b16 v[226:227], v1 offset:4352
  ds_read_b64_tr_b16 v[228:229], v1 offset:5120
  ds_read_b64_tr_b16 v[230:231], v1 offset:5376
  v_pk_mul_f32 v[180:181], v[180:181], v[196:197]
  v_pk_mul_f32 v[182:183], v[182:183], v[198:199]
  v_pk_mul_f32 v[184:185], v[184:185], v[200:201]
  v_pk_mul_f32 v[186:187], v[186:187], v[202:203]
  v_pk_mul_f32 v[188:189], v[188:189], v[204:205]
  v_pk_mul_f32 v[190:191], v[190:191], v[206:207]
  v_cvt_pk_bf16_f32 v176, v176, v177
  v_cvt_pk_bf16_f32 v177, v178, v179
  v_cvt_pk_bf16_f32 v178, v180, v181
  v_cvt_pk_bf16_f32 v179, v182, v183
  v_pk_fma_f32 v[192:193], v[160:161], v[160:161], s[44:45]
  v_pk_fma_f32 v[194:195], v[162:163], v[162:163], s[44:45]
  v_pk_fma_f32 v[196:197], v[164:165], v[164:165], s[44:45]
  v_pk_fma_f32 v[198:199], v[166:167], v[166:167], s[44:45]
  v_pk_fma_f32 v[200:201], v[168:169], v[168:169], s[44:45]
  v_pk_fma_f32 v[202:203], v[170:171], v[170:171], s[44:45]
  v_pk_fma_f32 v[204:205], v[172:173], v[172:173], s[44:45]
  v_pk_fma_f32 v[206:207], v[174:175], v[174:175], s[44:45]
  v_pk_mul_f32 v[192:193], v[192:193], v[160:161] neg_lo:[1,0] neg_hi:[1,0]
  v_pk_mul_f32 v[194:195], v[194:195], v[162:163] neg_lo:[1,0] neg_hi:[1,0]
  v_pk_mul_f32 v[196:197], v[196:197], v[164:165] neg_lo:[1,0] neg_hi:[1,0]
  v_pk_mul_f32 v[198:199], v[198:199], v[166:167] neg_lo:[1,0] neg_hi:[1,0]
  v_pk_mul_f32 v[200:201], v[200:201], v[168:169] neg_lo:[1,0] neg_hi:[1,0]
  v_pk_mul_f32 v[202:203], v[202:203], v[170:171] neg_lo:[1,0] neg_hi:[1,0]
  v_pk_mul_f32 v[204:205], v[204:205], v[172:173] neg_lo:[1,0] neg_hi:[1,0]
  v_pk_mul_f32 v[206:207], v[206:207], v[174:175] neg_lo:[1,0] neg_hi:[1,0]
  s_waitcnt lgkmcnt(12)
  v_mfma_f32_32x32x16_bf16 v[64:79], v[232:235], v[176:179], v[64:79]
  v_exp_f32 v192, v192
  v_exp_f32 v193, v193
  v_cvt_pk_bf16_f32 v184, v184, v185
  v_cvt_pk_bf16_f32 v185, v186, v187
  v_mfma_f32_32x32x16_bf16 v[80:95], v[236:239], v[176:179], v[80:95]
  v_exp_f32 v194, v194
  v_exp_f32 v195, v195
  v_cvt_pk_bf16_f32 v186, v188, v189
  v_cvt_pk_bf16_f32 v187, v190, v191
  v_mfma_f32_32x32x16_bf16 v[96:111], v[240:243], v[176:179], v[96:111]
  v_exp_f32 v196, v196
  v_exp_f32 v197, v197
  v_exp_f32 v198, v198
  v_mfma_f32_32x32x16_bf16 v[64:79], v[244:247], v[184:187], v[64:79]
  v_exp_f32 v199, v199
  v_exp_f32 v200, v200
  v_exp_f32 v201, v201
  v_mfma_f32_32x32x16_bf16 v[80:95], v[248:251], v[184:187], v[80:95]
  v_exp_f32 v202, v202
  v_exp_f32 v203, v203
  v_exp_f32 v204, v204
  v_mfma_f32_32x32x16_bf16 v[96:111], v[252:255], v[184:187], v[96:111]
  v_exp_f32 v205, v205
  v_exp_f32 v206, v206
  v_exp_f32 v207, v207
  v_fma_f32 v192, v192, s46, s46
  v_fma_f32 v193, v193, s46, s46
  v_pk_fma_f32 v[194:195], v[194:195], s[46:47], s[46:47]
  v_pk_fma_f32 v[196:197], v[196:197], s[46:47], s[46:47]
  v_pk_fma_f32 v[198:199], v[198:199], s[46:47], s[46:47]
  v_pk_fma_f32 v[200:201], v[200:201], s[46:47], s[46:47]
  v_pk_fma_f32 v[202:203], v[202:203], s[46:47], s[46:47]
  v_pk_fma_f32 v[204:205], v[204:205], s[46:47], s[46:47]
  v_pk_fma_f32 v[206:207], v[206:207], s[46:47], s[46:47]
  s_waitcnt lgkmcnt(0)
  v_mfma_f32_32x32x16_bf16 v[176:191], v[208:211], v[40:43], 0
  v_rcp_f32 v192, v192
  v_rcp_f32 v193, v193
  v_rcp_f32 v194, v194
  v_mfma_f32_32x32x16_bf16 v[176:191], v[212:215], v[44:47], v[176:191]
  v_rcp_f32 v195, v195
  v_rcp_f32 v196, v196
  v_rcp_f32 v197, v197
  v_mfma_f32_32x32x16_bf16 v[176:191], v[216:219], v[48:51], v[176:191]
  v_rcp_f32 v198, v198
  v_rcp_f32 v199, v199
  v_rcp_f32 v200, v200
  v_mfma_f32_32x32x16_bf16 v[176:191], v[220:223], v[52:55], v[176:191]
  v_rcp_f32 v201, v201
  v_rcp_f32 v202, v202
  v_rcp_f32 v203, v203
  v_mfma_f32_32x32x16_bf16 v[176:191], v[224:227], v[56:59], v[176:191]
  v_rcp_f32 v204, v204
  v_rcp_f32 v205, v205
  v_mul_f32 v160, v160, v192
  v_mul_f32 v161, v161, v193
  v_mfma_f32_32x32x16_bf16 v[176:191], v[228:231], v[60:63], v[176:191]
  v_rcp_f32 v206, v206
  v_rcp_f32 v207, v207
  v_mul_f32 v162, v162, v194
  v_mul_f32 v163, v163, v195
  ds_read_b64_tr_b16 v[208:209], v1 offset:49152
  ds_read_b64_tr_b16 v[210:211], v1 offset:49408
  ds_read_b64_tr_b16 v[212:213], v1 offset:50176
  ds_read_b64_tr_b16 v[214:215], v1 offset:50432
  ds_read_b64_tr_b16 v[216:217], v1 offset:51200
  ds_read_b64_tr_b16 v[218:219], v1 offset:51456
  ds_read_b64_tr_b16 v[220:221], v1 offset:52224
  ds_read_b64_tr_b16 v[222:223], v1 offset:52480
  ds_read_b64_tr_b16 v[224:225], v1 offset:53248
  ds_read_b64_tr_b16 v[226:227], v1 offset:53504
  ds_read_b64_tr_b16 v[228:229], v1 offset:54272
  ds_read_b64_tr_b16 v[230:231], v1 offset:54528
  v_pk_mul_f32 v[164:165], v[164:165], v[196:197]
  v_pk_mul_f32 v[166:167], v[166:167], v[198:199]
  v_pk_mul_f32 v[168:169], v[168:169], v[200:201]
  v_pk_mul_f32 v[170:171], v[170:171], v[202:203]
  v_pk_mul_f32 v[172:173], v[172:173], v[204:205]
  v_pk_mul_f32 v[174:175], v[174:175], v[206:207]
  v_cvt_pk_bf16_f32 v160, v160, v161
  v_cvt_pk_bf16_f32 v161, v162, v163
  v_cvt_pk_bf16_f32 v162, v164, v165
  v_cvt_pk_bf16_f32 v163, v166, v167
  v_pk_fma_f32 v[192:193], v[176:177], v[176:177], s[44:45]
  v_pk_fma_f32 v[194:195], v[178:179], v[178:179], s[44:45]
  v_pk_fma_f32 v[196:197], v[180:181], v[180:181], s[44:45]
  v_pk_fma_f32 v[198:199], v[182:183], v[182:183], s[44:45]
  v_pk_fma_f32 v[200:201], v[184:185], v[184:185], s[44:45]
  v_pk_fma_f32 v[202:203], v[186:187], v[186:187], s[44:45]
  v_pk_fma_f32 v[204:205], v[188:189], v[188:189], s[44:45]
  v_pk_fma_f32 v[206:207], v[190:191], v[190:191], s[44:45]
  v_pk_mul_f32 v[192:193], v[192:193], v[176:177] neg_lo:[1,0] neg_hi:[1,0]
  v_pk_mul_f32 v[194:195], v[194:195], v[178:179] neg_lo:[1,0] neg_hi:[1,0]
  v_pk_mul_f32 v[196:197], v[196:197], v[180:181] neg_lo:[1,0] neg_hi:[1,0]
  v_pk_mul_f32 v[198:199], v[198:199], v[182:183] neg_lo:[1,0] neg_hi:[1,0]
  v_pk_mul_f32 v[200:201], v[200:201], v[184:185] neg_lo:[1,0] neg_hi:[1,0]
  v_pk_mul_f32 v[202:203], v[202:203], v[186:187] neg_lo:[1,0] neg_hi:[1,0]
  v_pk_mul_f32 v[204:205], v[204:205], v[188:189] neg_lo:[1,0] neg_hi:[1,0]
  v_pk_mul_f32 v[206:207], v[206:207], v[190:191] neg_lo:[1,0] neg_hi:[1,0]
  v_cvt_pk_bf16_f32 v64, v64, v65
  v_cvt_pk_bf16_f32 v65, v66, v67
  v_cvt_pk_bf16_f32 v66, v68, v69
  v_cvt_pk_bf16_f32 v67, v70, v71
  v_cvt_pk_bf16_f32 v68, v72, v73
  v_cvt_pk_bf16_f32 v69, v74, v75
  v_cvt_pk_bf16_f32 v70, v76, v77
  v_cvt_pk_bf16_f32 v71, v78, v79
  v_cvt_pk_bf16_f32 v72, v80, v81
  v_cvt_pk_bf16_f32 v73, v82, v83
  v_cvt_pk_bf16_f32 v74, v84, v85
  v_cvt_pk_bf16_f32 v75, v86, v87
  v_cvt_pk_bf16_f32 v76, v88, v89
  v_cvt_pk_bf16_f32 v77, v90, v91
  v_cvt_pk_bf16_f32 v78, v92, v93
  v_cvt_pk_bf16_f32 v79, v94, v95
  v_cvt_pk_bf16_f32 v80, v96, v97
  v_cvt_pk_bf16_f32 v81, v98, v99
  v_cvt_pk_bf16_f32 v82, v100, v101
  v_cvt_pk_bf16_f32 v83, v102, v103
  v_cvt_pk_bf16_f32 v84, v104, v105
  v_cvt_pk_bf16_f32 v85, v106, v107
  v_cvt_pk_bf16_f32 v86, v108, v109
  v_cvt_pk_bf16_f32 v87, v110, v111
  v_permlane16_swap_b32 v64, v68
  v_permlane16_swap_b32 v65, v69
  v_permlane16_swap_b32 v66, v70
  v_permlane16_swap_b32 v67, v71
  v_permlane16_swap_b32 v72, v76
  v_permlane16_swap_b32 v73, v77
  v_permlane16_swap_b32 v74, v78
  v_permlane16_swap_b32 v75, v79
  v_permlane16_swap_b32 v80, v84
  v_permlane16_swap_b32 v81, v85
  v_permlane16_swap_b32 v82, v86
  v_permlane16_swap_b32 v83, v87
  v_mfma_f32_32x32x16_bf16 v[112:127], v[232:235], v[160:163], v[112:127]
  v_exp_f32 v192, v192
  v_exp_f32 v193, v193
  v_cvt_pk_bf16_f32 v168, v168, v169
  v_cvt_pk_bf16_f32 v169, v170, v171
  v_mfma_f32_32x32x16_bf16 v[128:143], v[236:239], v[160:163], v[128:143]
  v_exp_f32 v194, v194
  v_exp_f32 v195, v195
  v_cvt_pk_bf16_f32 v170, v172, v173
  v_cvt_pk_bf16_f32 v171, v174, v175
  v_mfma_f32_32x32x16_bf16 v[144:159], v[240:243], v[160:163], v[144:159]
  v_exp_f32 v196, v196
  v_exp_f32 v197, v197
  v_exp_f32 v198, v198
  v_mfma_f32_32x32x16_bf16 v[112:127], v[244:247], v[168:171], v[112:127]
  v_exp_f32 v199, v199
  v_exp_f32 v200, v200
  v_exp_f32 v201, v201
  v_mfma_f32_32x32x16_bf16 v[128:143], v[248:251], v[168:171], v[128:143]
  v_exp_f32 v202, v202
  v_exp_f32 v203, v203
  v_exp_f32 v204, v204
  v_mfma_f32_32x32x16_bf16 v[144:159], v[252:255], v[168:171], v[144:159]
  v_exp_f32 v205, v205
  v_exp_f32 v206, v206
  v_exp_f32 v207, v207
  v_subrev_u32 v2, 73728, v2
  ds_read_b64_tr_b16 v[232:233], v2 offset:6144
  ds_read_b64_tr_b16 v[234:235], v2 offset:6912
  ds_read_b64_tr_b16 v[236:237], v2 offset:6208
  ds_read_b64_tr_b16 v[238:239], v2 offset:6976
  ds_read_b64_tr_b16 v[240:241], v2 offset:6272
  ds_read_b64_tr_b16 v[242:243], v2 offset:7040
  ds_read_b64_tr_b16 v[244:245], v2 offset:9216
  ds_read_b64_tr_b16 v[246:247], v2 offset:9984
  ds_read_b64_tr_b16 v[248:249], v2 offset:9280
  ds_read_b64_tr_b16 v[250:251], v2 offset:10048
  ds_read_b64_tr_b16 v[252:253], v2 offset:9344
  ds_read_b64_tr_b16 v[254:255], v2 offset:10112
  buffer_store_dwordx4 v[64:67], v14, s[8:11], s56 offen offset:0 sc1
  v_pk_fma_f32 v[192:193], v[192:193], s[46:47], s[46:47]
  v_pk_fma_f32 v[194:195], v[194:195], s[46:47], s[46:47]
  v_pk_fma_f32 v[196:197], v[196:197], s[46:47], s[46:47]
  v_pk_fma_f32 v[198:199], v[198:199], s[46:47], s[46:47]
  v_pk_fma_f32 v[200:201], v[200:201], s[46:47], s[46:47]
  v_pk_fma_f32 v[202:203], v[202:203], s[46:47], s[46:47]
  v_pk_fma_f32 v[204:205], v[204:205], s[46:47], s[46:47]
  v_pk_fma_f32 v[206:207], v[206:207], s[46:47], s[46:47]
  s_waitcnt lgkmcnt(12)
  v_mfma_f32_32x32x16_bf16 v[160:175], v[208:211], v[40:43], 0
  v_rcp_f32 v192, v192
  v_rcp_f32 v193, v193
  v_rcp_f32 v194, v194
  v_mfma_f32_32x32x16_bf16 v[160:175], v[212:215], v[44:47], v[160:175]
  v_rcp_f32 v195, v195
  v_rcp_f32 v196, v196
  v_rcp_f32 v197, v197
  v_mfma_f32_32x32x16_bf16 v[160:175], v[216:219], v[48:51], v[160:175]
  v_rcp_f32 v198, v198
  v_rcp_f32 v199, v199
  v_rcp_f32 v200, v200
  v_mfma_f32_32x32x16_bf16 v[160:175], v[220:223], v[52:55], v[160:175]
  v_rcp_f32 v201, v201
  v_rcp_f32 v202, v202
  v_rcp_f32 v203, v203
  v_mfma_f32_32x32x16_bf16 v[160:175], v[224:227], v[56:59], v[160:175]
  v_rcp_f32 v204, v204
  v_rcp_f32 v205, v205
  v_mul_f32 v176, v176, v192
  v_mul_f32 v177, v177, v193
  v_mfma_f32_32x32x16_bf16 v[160:175], v[228:231], v[60:63], v[160:175]
  v_rcp_f32 v206, v206
  v_rcp_f32 v207, v207
  v_mul_f32 v178, v178, v194
  v_mul_f32 v179, v179, v195
  v_add_u32 v1, 12288, v1
  ds_read_b64_tr_b16 v[208:209], v1 offset:49152
  ds_read_b64_tr_b16 v[210:211], v1 offset:49408
  ds_read_b64_tr_b16 v[212:213], v1 offset:50176
  ds_read_b64_tr_b16 v[214:215], v1 offset:50432
  ds_read_b64_tr_b16 v[216:217], v1 offset:51200
  ds_read_b64_tr_b16 v[218:219], v1 offset:51456
  ds_read_b64_tr_b16 v[220:221], v1 offset:52224
  ds_read_b64_tr_b16 v[222:223], v1 offset:52480
  ds_read_b64_tr_b16 v[224:225], v1 offset:53248
  ds_read_b64_tr_b16 v[226:227], v1 offset:53504
  ds_read_b64_tr_b16 v[228:229], v1 offset:54272
  ds_read_b64_tr_b16 v[230:231], v1 offset:54528
  buffer_store_dwordx4 v[68:71], v14, s[8:11], s56 offen offset:192 sc1
  v_pk_mul_f32 v[180:181], v[180:181], v[196:197]
  v_pk_mul_f32 v[182:183], v[182:183], v[198:199]
  v_pk_mul_f32 v[184:185], v[184:185], v[200:201]
  v_pk_mul_f32 v[186:187], v[186:187], v[202:203]
  v_pk_mul_f32 v[188:189], v[188:189], v[204:205]
  v_pk_mul_f32 v[190:191], v[190:191], v[206:207]
  v_cvt_pk_bf16_f32 v176, v176, v177
  v_cvt_pk_bf16_f32 v177, v178, v179
  v_cvt_pk_bf16_f32 v178, v180, v181
  v_cvt_pk_bf16_f32 v179, v182, v183
  v_pk_fma_f32 v[192:193], v[160:161], v[160:161], s[44:45]
  v_pk_fma_f32 v[194:195], v[162:163], v[162:163], s[44:45]
  v_pk_fma_f32 v[196:197], v[164:165], v[164:165], s[44:45]
  v_pk_fma_f32 v[198:199], v[166:167], v[166:167], s[44:45]
  v_pk_fma_f32 v[200:201], v[168:169], v[168:169], s[44:45]
  v_pk_fma_f32 v[202:203], v[170:171], v[170:171], s[44:45]
  v_pk_fma_f32 v[204:205], v[172:173], v[172:173], s[44:45]
  v_pk_fma_f32 v[206:207], v[174:175], v[174:175], s[44:45]
  v_pk_mul_f32 v[192:193], v[192:193], v[160:161] neg_lo:[1,0] neg_hi:[1,0]
  v_pk_mul_f32 v[194:195], v[194:195], v[162:163] neg_lo:[1,0] neg_hi:[1,0]
  v_pk_mul_f32 v[196:197], v[196:197], v[164:165] neg_lo:[1,0] neg_hi:[1,0]
  v_pk_mul_f32 v[198:199], v[198:199], v[166:167] neg_lo:[1,0] neg_hi:[1,0]
  v_pk_mul_f32 v[200:201], v[200:201], v[168:169] neg_lo:[1,0] neg_hi:[1,0]
  v_pk_mul_f32 v[202:203], v[202:203], v[170:171] neg_lo:[1,0] neg_hi:[1,0]
  v_pk_mul_f32 v[204:205], v[204:205], v[172:173] neg_lo:[1,0] neg_hi:[1,0]
  v_pk_mul_f32 v[206:207], v[206:207], v[174:175] neg_lo:[1,0] neg_hi:[1,0]
  s_cmp_ge_u32 s28, 4
  s_cbranch_scc1 L_tailB
  s_waitcnt lgkmcnt(12)
  v_mfma_f32_32x32x16_bf16 v[112:127], v[232:235], v[176:179], v[112:127]
  v_exp_f32 v192, v192
  v_exp_f32 v193, v193
  v_cvt_pk_bf16_f32 v184, v184, v185
  v_cvt_pk_bf16_f32 v185, v186, v187
  v_mfma_f32_32x32x16_bf16 v[128:143], v[236:239], v[176:179], v[128:143]
  v_exp_f32 v194, v194
  v_exp_f32 v195, v195
  v_cvt_pk_bf16_f32 v186, v188, v189
  v_cvt_pk_bf16_f32 v187, v190, v191
  v_mfma_f32_32x32x16_bf16 v[144:159], v[240:243], v[176:179], v[144:159]
  v_exp_f32 v196, v196
  v_exp_f32 v197, v197
  v_exp_f32 v198, v198
  v_mfma_f32_32x32x16_bf16 v[112:127], v[244:247], v[184:187], v[112:127]
  v_exp_f32 v199, v199
  v_exp_f32 v200, v200
  v_exp_f32 v201, v201
  v_mfma_f32_32x32x16_bf16 v[128:143], v[248:251], v[184:187], v[128:143]
  v_exp_f32 v202, v202
  v_exp_f32 v203, v203
  v_exp_f32 v204, v204
  v_mfma_f32_32x32x16_bf16 v[144:159], v[252:255], v[184:187], v[144:159]
  v_exp_f32 v205, v205
  v_exp_f32 v206, v206
  v_exp_f32 v207, v207
  ds_read_b64_tr_b16 v[232:233], v2 offset:55296
  ds_read_b64_tr_b16 v[234:235], v2 offset:56064
  ds_read_b64_tr_b16 v[236:237], v2 offset:55360
  ds_read_b64_tr_b16 v[238:239], v2 offset:56128
  ds_read_b64_tr_b16 v[240:241], v2 offset:55424
  ds_read_b64_tr_b16 v[242:243], v2 offset:56192
  ds_read_b64_tr_b16 v[244:245], v2 offset:58368
  ds_read_b64_tr_b16 v[246:247], v2 offset:59136
  ds_read_b64_tr_b16 v[248:249], v2 offset:58432
  ds_read_b64_tr_b16 v[250:251], v2 offset:59200
  ds_read_b64_tr_b16 v[252:253], v2 offset:58496
  ds_read_b64_tr_b16 v[254:255], v2 offset:59264
  buffer_store_dwordx4 v[72:75], v14, s[8:11], s56 offen offset:64 sc1
  v_pk_fma_f32 v[192:193], v[192:193], s[46:47], s[46:47]
  v_pk_fma_f32 v[194:195], v[194:195], s[46:47], s[46:47]
  v_pk_fma_f32 v[196:197], v[196:197], s[46:47], s[46:47]
  v_pk_fma_f32 v[198:199], v[198:199], s[46:47], s[46:47]
  v_pk_fma_f32 v[200:201], v[200:201], s[46:47], s[46:47]
  v_pk_fma_f32 v[202:203], v[202:203], s[46:47], s[46:47]
  v_pk_fma_f32 v[204:205], v[204:205], s[46:47], s[46:47]
  v_pk_fma_f32 v[206:207], v[206:207], s[46:47], s[46:47]
  s_waitcnt lgkmcnt(12)
  v_mfma_f32_32x32x16_bf16 v[176:191], v[208:211], v[40:43], 0
  v_rcp_f32 v192, v192
  v_rcp_f32 v193, v193
  v_rcp_f32 v194, v194
  v_mfma_f32_32x32x16_bf16 v[176:191], v[212:215], v[44:47], v[176:191]
  v_rcp_f32 v195, v195
  v_rcp_f32 v196, v196
  v_rcp_f32 v197, v197
  v_mfma_f32_32x32x16_bf16 v[176:191], v[216:219], v[48:51], v[176:191]
  v_rcp_f32 v198, v198
  v_rcp_f32 v199, v199
  v_rcp_f32 v200, v200
  v_mfma_f32_32x32x16_bf16 v[176:191], v[220:223], v[52:55], v[176:191]
  v_rcp_f32 v201, v201
  v_rcp_f32 v202, v202
  v_rcp_f32 v203, v203
  v_mfma_f32_32x32x16_bf16 v[176:191], v[224:227], v[56:59], v[176:191]
  v_rcp_f32 v204, v204
  v_rcp_f32 v205, v205
  v_mul_f32 v160, v160, v192
  v_mul_f32 v161, v161, v193
  v_mfma_f32_32x32x16_bf16 v[176:191], v[228:231], v[60:63], v[176:191]
  v_rcp_f32 v206, v206
  v_rcp_f32 v207, v207
  v_mul_f32 v162, v162, v194
  v_mul_f32 v163, v163, v195
  v_mul_f32 v164, v164, v196
  v_mul_f32 v165, v165, v197
  buffer_store_dwordx4 v[76:79], v14, s[8:11], s56 offen offset:256 sc1
  v_pk_mul_f32 v[166:167], v[166:167], v[198:199]
  v_pk_mul_f32 v[168:169], v[168:169], v[200:201]
  v_pk_mul_f32 v[170:171], v[170:171], v[202:203]
  v_pk_mul_f32 v[172:173], v[172:173], v[204:205]
  v_pk_mul_f32 v[174:175], v[174:175], v[206:207]
  v_cvt_pk_bf16_f32 v160, v160, v161
  v_cvt_pk_bf16_f32 v161, v162, v163
  v_cvt_pk_bf16_f32 v162, v164, v165
  v_cvt_pk_bf16_f32 v163, v166, v167
  v_pk_fma_f32 v[192:193], v[176:177], v[176:177], s[44:45]
  v_pk_fma_f32 v[194:195], v[178:179], v[178:179], s[44:45]
  v_pk_fma_f32 v[196:197], v[180:181], v[180:181], s[44:45]
  v_pk_fma_f32 v[198:199], v[182:183], v[182:183], s[44:45]
  v_pk_fma_f32 v[200:201], v[184:185], v[184:185], s[44:45]
  v_pk_fma_f32 v[202:203], v[186:187], v[186:187], s[44:45]
  v_pk_fma_f32 v[204:205], v[188:189], v[188:189], s[44:45]
  v_pk_fma_f32 v[206:207], v[190:191], v[190:191], s[44:45]
  v_pk_mul_f32 v[192:193], v[192:193], v[176:177] neg_lo:[1,0] neg_hi:[1,0]
  v_pk_mul_f32 v[194:195], v[194:195], v[178:179] neg_lo:[1,0] neg_hi:[1,0]
  v_pk_mul_f32 v[196:197], v[196:197], v[180:181] neg_lo:[1,0] neg_hi:[1,0]
  v_pk_mul_f32 v[198:199], v[198:199], v[182:183] neg_lo:[1,0] neg_hi:[1,0]
  v_pk_mul_f32 v[200:201], v[200:201], v[184:185] neg_lo:[1,0] neg_hi:[1,0]
  v_pk_mul_f32 v[202:203], v[202:203], v[186:187] neg_lo:[1,0] neg_hi:[1,0]
  v_pk_mul_f32 v[204:205], v[204:205], v[188:189] neg_lo:[1,0] neg_hi:[1,0]
  v_pk_mul_f32 v[206:207], v[206:207], v[190:191] neg_lo:[1,0] neg_hi:[1,0]
  s_waitcnt lgkmcnt(0)
  v_mfma_f32_32x32x16_bf16 v[112:127], v[232:235], v[160:163], v[112:127]
  v_exp_f32 v192, v192
  v_exp_f32 v193, v193
  v_cvt_pk_bf16_f32 v168, v168, v169
  v_cvt_pk_bf16_f32 v169, v170, v171
  v_mfma_f32_32x32x16_bf16 v[128:143], v[236:239], v[160:163], v[128:143]
  v_exp_f32 v194, v194
  v_exp_f32 v195, v195
  v_cvt_pk_bf16_f32 v170, v172, v173
  v_cvt_pk_bf16_f32 v171, v174, v175
  v_mfma_f32_32x32x16_bf16 v[144:159], v[240:243], v[160:163], v[144:159]
  v_exp_f32 v196, v196
  v_exp_f32 v197, v197
  v_exp_f32 v198, v198
  v_mfma_f32_32x32x16_bf16 v[112:127], v[244:247], v[168:171], v[112:127]
  v_exp_f32 v199, v199
  v_exp_f32 v200, v200
  v_exp_f32 v201, v201
  v_mfma_f32_32x32x16_bf16 v[128:143], v[248:251], v[168:171], v[128:143]
  v_exp_f32 v202, v202
  v_exp_f32 v203, v203
  v_exp_f32 v204, v204
  v_mfma_f32_32x32x16_bf16 v[144:159], v[252:255], v[168:171], v[144:159]
  v_exp_f32 v205, v205
  v_exp_f32 v206, v206
  v_exp_f32 v207, v207
  v_add_u32 v2, 12288, v2
  ds_read_b64_tr_b16 v[232:233], v2 offset:55296
  ds_read_b64_tr_b16 v[234:235], v2 offset:56064
  ds_read_b64_tr_b16 v[236:237], v2 offset:55360
  ds_read_b64_tr_b16 v[238:239], v2 offset:56128
  ds_read_b64_tr_b16 v[240:241], v2 offset:55424
  ds_read_b64_tr_b16 v[242:243], v2 offset:56192
  ds_read_b64_tr_b16 v[244:245], v2 offset:58368
  ds_read_b64_tr_b16 v[246:247], v2 offset:59136
  ds_read_b64_tr_b16 v[248:249], v2 offset:58432
  ds_read_b64_tr_b16 v[250:251], v2 offset:59200
  ds_read_b64_tr_b16 v[252:253], v2 offset:58496
  ds_read_b64_tr_b16 v[254:255], v2 offset:59264
  buffer_store_dwordx4 v[80:83], v14, s[8:11], s56 offen offset:128 sc1
  v_pk_fma_f32 v[192:193], v[192:193], s[46:47], s[46:47]
  v_pk_fma_f32 v[194:195], v[194:195], s[46:47], s[46:47]
  v_pk_fma_f32 v[196:197], v[196:197], s[46:47], s[46:47]
  v_pk_fma_f32 v[198:199], v[198:199], s[46:47], s[46:47]
  v_pk_fma_f32 v[200:201], v[200:201], s[46:47], s[46:47]
  v_pk_fma_f32 v[202:203], v[202:203], s[46:47], s[46:47]
  v_pk_fma_f32 v[204:205], v[204:205], s[46:47], s[46:47]
  v_pk_fma_f32 v[206:207], v[206:207], s[46:47], s[46:47]
  v_rcp_f32 v192, v192
  v_rcp_f32 v193, v193
  v_rcp_f32 v194, v194
  v_rcp_f32 v195, v195
  v_rcp_f32 v196, v196
  v_rcp_f32 v197, v197
  v_rcp_f32 v198, v198
  v_rcp_f32 v199, v199
  v_rcp_f32 v200, v200
  v_rcp_f32 v201, v201
  v_rcp_f32 v202, v202
  v_rcp_f32 v203, v203
  v_rcp_f32 v204, v204
  v_rcp_f32 v205, v205
  v_mul_f32 v176, v176, v192
  v_mul_f32 v177, v177, v193
  v_rcp_f32 v206, v206
  v_rcp_f32 v207, v207
  v_mul_f32 v178, v178, v194
  v_mul_f32 v179, v179, v195
  v_mul_f32 v180, v180, v196
  v_mul_f32 v181, v181, v197
  buffer_store_dwordx4 v[84:87], v14, s[8:11], s56 offen offset:320 sc1
  v_pk_mul_f32 v[182:183], v[182:183], v[198:199]
  v_pk_mul_f32 v[184:185], v[184:185], v[200:201]
  v_pk_mul_f32 v[186:187], v[186:187], v[202:203]
  v_pk_mul_f32 v[188:189], v[188:189], v[204:205]
  v_pk_mul_f32 v[190:191], v[190:191], v[206:207]
  v_cvt_pk_bf16_f32 v176, v176, v177
  v_cvt_pk_bf16_f32 v177, v178, v179
  v_cvt_pk_bf16_f32 v178, v180, v181
  v_cvt_pk_bf16_f32 v179, v182, v183
  v_cvt_pk_bf16_f32 v184, v184, v185
  v_cvt_pk_bf16_f32 v185, v186, v187
  v_cvt_pk_bf16_f32 v186, v188, v189
  v_cvt_pk_bf16_f32 v187, v190, v191
  s_waitcnt lgkmcnt(0)
  v_mfma_f32_32x32x16_bf16 v[112:127], v[232:235], v[176:179], v[112:127]
  v_mfma_f32_32x32x16_bf16 v[128:143], v[236:239], v[176:179], v[128:143]
  v_mfma_f32_32x32x16_bf16 v[144:159], v[240:243], v[176:179], v[144:159]
  v_mfma_f32_32x32x16_bf16 v[112:127], v[244:247], v[184:187], v[112:127]
  v_mfma_f32_32x32x16_bf16 v[128:143], v[248:251], v[184:187], v[128:143]
  v_mfma_f32_32x32x16_bf16 v[144:159], v[252:255], v[184:187], v[144:159]
  s_nop 10
  v_cvt_pk_bf16_f32 v112, v112, v113
  v_cvt_pk_bf16_f32 v113, v114, v115
  v_cvt_pk_bf16_f32 v114, v116, v117
  v_cvt_pk_bf16_f32 v115, v118, v119
  v_cvt_pk_bf16_f32 v116, v120, v121
  v_cvt_pk_bf16_f32 v117, v122, v123
  v_cvt_pk_bf16_f32 v118, v124, v125
  v_cvt_pk_bf16_f32 v119, v126, v127
  v_cvt_pk_bf16_f32 v120, v128, v129
  v_cvt_pk_bf16_f32 v121, v130, v131
  v_cvt_pk_bf16_f32 v122, v132, v133
  v_cvt_pk_bf16_f32 v123, v134, v135
  v_cvt_pk_bf16_f32 v124, v136, v137
  v_cvt_pk_bf16_f32 v125, v138, v139
  v_cvt_pk_bf16_f32 v126, v140, v141
  v_cvt_pk_bf16_f32 v127, v142, v143
  v_cvt_pk_bf16_f32 v128, v144, v145
  v_cvt_pk_bf16_f32 v129, v146, v147
  v_cvt_pk_bf16_f32 v130, v148, v149
  v_cvt_pk_bf16_f32 v131, v150, v151
  v_cvt_pk_bf16_f32 v132, v152, v153
  v_cvt_pk_bf16_f32 v133, v154, v155
  v_cvt_pk_bf16_f32 v134, v156, v157
  v_cvt_pk_bf16_f32 v135, v158, v159
  v_permlane16_swap_b32 v112, v116
  v_permlane16_swap_b32 v113, v117
  v_permlane16_swap_b32 v114, v118
  v_permlane16_swap_b32 v115, v119
  v_permlane16_swap_b32 v120, v124
  v_permlane16_swap_b32 v121, v125
  v_permlane16_swap_b32 v122, v126
  v_permlane16_swap_b32 v123, v127
  v_permlane16_swap_b32 v128, v132
  v_permlane16_swap_b32 v129, v133
  v_permlane16_swap_b32 v130, v134
  v_permlane16_swap_b32 v131, v135
  buffer_store_dwordx4 v[112:115], v14, s[8:11], s57 offen offset:0 sc1
  buffer_store_dwordx4 v[116:119], v14, s[8:11], s57 offen offset:192 sc1
  buffer_store_dwordx4 v[120:123], v14, s[8:11], s57 offen offset:64 sc1
  buffer_store_dwordx4 v[124:127], v14, s[8:11], s57 offen offset:256 sc1
  buffer_store_dwordx4 v[128:131], v14, s[8:11], s57 offen offset:128 sc1
  buffer_store_dwordx4 v[132:135], v14, s[8:11], s57 offen offset:320 sc1
  s_barrier
  s_barrier
  s_branch L_fin
L_tailB:
  s_waitcnt lgkmcnt(12)
  v_mfma_f32_32x32x16_bf16 v[112:127], v[232:235], v[176:179], v[112:127]
  v_exp_f32 v192, v192
  v_exp_f32 v193, v193
  v_cvt_pk_bf16_f32 v184, v184, v185
  v_cvt_pk_bf16_f32 v185, v186, v187
  v_mfma_f32_32x32x16_bf16 v[128:143], v[236:239], v[176:179], v[128:143]
  v_exp_f32 v194, v194
  v_exp_f32 v195, v195
  v_cvt_pk_bf16_f32 v186, v188, v189
  v_cvt_pk_bf16_f32 v187, v190, v191
  v_mfma_f32_32x32x16_bf16 v[144:159], v[240:243], v[176:179], v[144:159]
  v_exp_f32 v196, v196
  v_exp_f32 v197, v197
  v_exp_f32 v198, v198
  v_mfma_f32_32x32x16_bf16 v[112:127], v[244:247], v[184:187], v[112:127]
  v_exp_f32 v199, v199
  v_exp_f32 v200, v200
  v_exp_f32 v201, v201
  v_mfma_f32_32x32x16_bf16 v[128:143], v[248:251], v[184:187], v[128:143]
  v_exp_f32 v202, v202
  v_exp_f32 v203, v203
  v_exp_f32 v204, v204
  v_mfma_f32_32x32x16_bf16 v[144:159], v[252:255], v[184:187], v[144:159]
  v_exp_f32 v205, v205
  v_exp_f32 v206, v206
  v_exp_f32 v207, v207
  ds_read_b64_tr_b16 v[232:233], v2 offset:55296
  ds_read_b64_tr_b16 v[234:235], v2 offset:56064
  ds_read_b64_tr_b16 v[236:237], v2 offset:55360
  ds_read_b64_tr_b16 v[238:239], v2 offset:56128
  ds_read_b64_tr_b16 v[240:241], v2 offset:55424
  ds_read_b64_tr_b16 v[242:243], v2 offset:56192
  ds_read_b64_tr_b16 v[244:245], v2 offset:58368
  ds_read_b64_tr_b16 v[246:247], v2 offset:59136
  ds_read_b64_tr_b16 v[248:249], v2 offset:58432
  ds_read_b64_tr_b16 v[250:251], v2 offset:59200
  ds_read_b64_tr_b16 v[252:253], v2 offset:58496
  ds_read_b64_tr_b16 v[254:255], v2 offset:59264
  buffer_store_dwordx4 v[72:75], v14, s[8:11], s56 offen offset:64 sc1
  v_pk_fma_f32 v[192:193], v[192:193], s[46:47], s[46:47]
  v_pk_fma_f32 v[194:195], v[194:195], s[46:47], s[46:47]
  v_pk_fma_f32 v[196:197], v[196:197], s[46:47], s[46:47]
  v_pk_fma_f32 v[198:199], v[198:199], s[46:47], s[46:47]
  v_pk_fma_f32 v[200:201], v[200:201], s[46:47], s[46:47]
  v_pk_fma_f32 v[202:203], v[202:203], s[46:47], s[46:47]
  v_pk_fma_f32 v[204:205], v[204:205], s[46:47], s[46:47]
  v_pk_fma_f32 v[206:207], v[206:207], s[46:47], s[46:47]
  s_waitcnt lgkmcnt(12)
  v_mfma_f32_32x32x16_bf16 v[176:191], v[208:211], v[40:43], 0
  v_rcp_f32 v192, v192
  v_rcp_f32 v193, v193
  v_rcp_f32 v194, v194
  v_mfma_f32_32x32x16_bf16 v[176:191], v[212:215], v[44:47], v[176:191]
  v_rcp_f32 v195, v195
  v_rcp_f32 v196, v196
  v_rcp_f32 v197, v197
  v_mfma_f32_32x32x16_bf16 v[176:191], v[216:219], v[48:51], v[176:191]
  v_rcp_f32 v198, v198
  v_rcp_f32 v199, v199
  v_rcp_f32 v200, v200
  v_mfma_f32_32x32x16_bf16 v[176:191], v[220:223], v[52:55], v[176:191]
  v_rcp_f32 v201, v201
  v_rcp_f32 v202, v202
  v_rcp_f32 v203, v203
  v_mfma_f32_32x32x16_bf16 v[176:191], v[224:227], v[56:59], v[176:191]
  v_rcp_f32 v204, v204
  v_rcp_f32 v205, v205
  v_mul_f32 v160, v160, v192
  v_mul_f32 v161, v161, v193
  v_mfma_f32_32x32x16_bf16 v[176:191], v[228:231], v[60:63], v[176:191]
  v_rcp_f32 v206, v206
  v_rcp_f32 v207, v207
  v_mul_f32 v162, v162, v194
  v_mul_f32 v163, v163, v195
  s_lshr_b32 s30, s19, 1
  s_mul_i32 s31, s30, 6144
  s_add_u32 s31, s31, 151552
  v_add_u32 v5, s31, v4
  ds_read_b128 v[16:19], v5 offset:0
  ds_read_b128 v[20:23], v5 offset:1024
  ds_read_b128 v[24:27], v5 offset:2048
  ds_read_b128 v[28:31], v5 offset:3072
  ds_read_b128 v[32:35], v5 offset:4096
  ds_read_b128 v[36:39], v5 offset:5120
  v_bfe_u32 v6, v0, 1, 3
  s_mov_b32 s31, 73728
  v_mul_lo_u32 v6, v6, s31
  v_sub_u32 v9, v3, v6
  s_mul_i32 s30, s30, 384
  s_add_u32 s30, s30, s38
  s_and_b32 s31, s19, 1
  s_mul_i32 s31, s31, 128
  s_add_u32 s50, s30, s31
  v_sub_u32 v15, v14, v6
  s_and_b32 s30, s28, 1
  s_mul_i32 s30, s30, 73728
  s_sub_u32 s30, s30, 12288
  v_add_u32 v1, s30, v1
  ds_read_b64_tr_b16 v[208:209], v1 offset:0
  ds_read_b64_tr_b16 v[210:211], v1 offset:256
  ds_read_b64_tr_b16 v[212:213], v1 offset:1024
  ds_read_b64_tr_b16 v[214:215], v1 offset:1280
  ds_read_b64_tr_b16 v[216:217], v1 offset:2048
  ds_read_b64_tr_b16 v[218:219], v1 offset:2304
  ds_read_b64_tr_b16 v[220:221], v1 offset:3072
  ds_read_b64_tr_b16 v[222:223], v1 offset:3328
  ds_read_b64_tr_b16 v[224:225], v1 offset:4096
  ds_read_b64_tr_b16 v[226:227], v1 offset:4352
  ds_read_b64_tr_b16 v[228:229], v1 offset:5120
  ds_read_b64_tr_b16 v[230:231], v1 offset:5376
  buffer_store_dwordx4 v[76:79], v14, s[8:11], s56 offen offset:256 sc1
  v_pk_mul_f32 v[164:165], v[164:165], v[196:197]
  v_pk_mul_f32 v[166:167], v[166:167], v[198:199]
  v_pk_mul_f32 v[168:169], v[168:169], v[200:201]
  v_pk_mul_f32 v[170:171], v[170:171], v[202:203]
  v_pk_mul_f32 v[172:173], v[172:173], v[204:205]
  v_pk_mul_f32 v[174:175], v[174:175], v[206:207]
  v_cvt_pk_bf16_f32 v160, v160, v161
  v_cvt_pk_bf16_f32 v161, v162, v163
  v_cvt_pk_bf16_f32 v162, v164, v165
  v_cvt_pk_bf16_f32 v163, v166, v167
  v_pk_fma_f32 v[192:193], v[176:177], v[176:177], s[44:45]
  v_pk_fma_f32 v[194:195], v[178:179], v[178:179], s[44:45]
  v_pk_fma_f32 v[196:197], v[180:181], v[180:181], s[44:45]
  v_pk_fma_f32 v[198:199], v[182:183], v[182:183], s[44:45]
  v_pk_fma_f32 v[200:201], v[184:185], v[184:185], s[44:45]
  v_pk_fma_f32 v[202:203], v[186:187], v[186:187], s[44:45]
  v_pk_fma_f32 v[204:205], v[188:189], v[188:189], s[44:45]
  v_pk_fma_f32 v[206:207], v[190:191], v[190:191], s[44:45]
  v_pk_mul_f32 v[192:193], v[192:193], v[176:177] neg_lo:[1,0] neg_hi:[1,0]
  v_pk_mul_f32 v[194:195], v[194:195], v[178:179] neg_lo:[1,0] neg_hi:[1,0]
  v_pk_mul_f32 v[196:197], v[196:197], v[180:181] neg_lo:[1,0] neg_hi:[1,0]
  v_pk_mul_f32 v[198:199], v[198:199], v[182:183] neg_lo:[1,0] neg_hi:[1,0]
  v_pk_mul_f32 v[200:201], v[200:201], v[184:185] neg_lo:[1,0] neg_hi:[1,0]
  v_pk_mul_f32 v[202:203], v[202:203], v[186:187] neg_lo:[1,0] neg_hi:[1,0]
  v_pk_mul_f32 v[204:205], v[204:205], v[188:189] neg_lo:[1,0] neg_hi:[1,0]
  v_pk_mul_f32 v[206:207], v[206:207], v[190:191] neg_lo:[1,0] neg_hi:[1,0]
  s_waitcnt lgkmcnt(14)
  v_mfma_f32_32x32x16_bf16 v[112:127], v[232:235], v[160:163], v[112:127]
  v_exp_f32 v192, v192
  v_exp_f32 v193, v193
  v_cvt_pk_bf16_f32 v168, v168, v169
  v_cvt_pk_bf16_f32 v169, v170, v171
  v_mfma_f32_32x32x16_bf16 v[128:143], v[236:239], v[160:163], v[128:143]
  v_exp_f32 v194, v194
  v_exp_f32 v195, v195
  v_cvt_pk_bf16_f32 v170, v172, v173
  v_cvt_pk_bf16_f32 v171, v174, v175
  v_mfma_f32_32x32x16_bf16 v[144:159], v[240:243], v[160:163], v[144:159]
  v_exp_f32 v196, v196
  v_exp_f32 v197, v197
  v_exp_f32 v198, v198
  v_mfma_f32_32x32x16_bf16 v[112:127], v[244:247], v[168:171], v[112:127]
  v_exp_f32 v199, v199
  v_exp_f32 v200, v200
  v_exp_f32 v201, v201
  v_mfma_f32_32x32x16_bf16 v[128:143], v[248:251], v[168:171], v[128:143]
  v_exp_f32 v202, v202
  v_exp_f32 v203, v203
  v_exp_f32 v204, v204
  v_mfma_f32_32x32x16_bf16 v[144:159], v[252:255], v[168:171], v[144:159]
  v_exp_f32 v205, v205
  v_exp_f32 v206, v206
  v_exp_f32 v207, v207
  v_add_u32 v2, 12288, v2
  ds_read_b64_tr_b16 v[232:233], v2 offset:55296
  ds_read_b64_tr_b16 v[234:235], v2 offset:56064
  ds_read_b64_tr_b16 v[236:237], v2 offset:55360
  ds_read_b64_tr_b16 v[238:239], v2 offset:56128
  ds_read_b64_tr_b16 v[240:241], v2 offset:55424
  ds_read_b64_tr_b16 v[242:243], v2 offset:56192
  ds_read_b64_tr_b16 v[244:245], v2 offset:58368
  ds_read_b64_tr_b16 v[246:247], v2 offset:59136
  ds_read_b64_tr_b16 v[248:249], v2 offset:58432
  ds_read_b64_tr_b16 v[250:251], v2 offset:59200
  ds_read_b64_tr_b16 v[252:253], v2 offset:58496
  ds_read_b64_tr_b16 v[254:255], v2 offset:59264
  buffer_store_dwordx4 v[80:83], v14, s[8:11], s56 offen offset:128 sc1
  v_pk_fma_f32 v[192:193], v[192:193], s[46:47], s[46:47]
  v_pk_fma_f32 v[194:195], v[194:195], s[46:47], s[46:47]
  v_pk_fma_f32 v[196:197], v[196:197], s[46:47], s[46:47]
  v_pk_fma_f32 v[198:199], v[198:199], s[46:47], s[46:47]
  v_pk_fma_f32 v[200:201], v[200:201], s[46:47], s[46:47]
  v_pk_fma_f32 v[202:203], v[202:203], s[46:47], s[46:47]
  v_pk_fma_f32 v[204:205], v[204:205], s[46:47], s[46:47]
  v_pk_fma_f32 v[206:207], v[206:207], s[46:47], s[46:47]
  s_waitcnt lgkmcnt(12)
  v_mfma_f32_32x32x16_bf16 v[160:175], v[208:211], v[16:19], 0
  v_rcp_f32 v192, v192
  v_rcp_f32 v193, v193
  v_rcp_f32 v194, v194
  v_mfma_f32_32x32x16_bf16 v[160:175], v[212:215], v[20:23], v[160:175]
  v_rcp_f32 v195, v195
  v_rcp_f32 v196, v196
  v_rcp_f32 v197, v197
  v_mfma_f32_32x32x16_bf16 v[160:175], v[216:219], v[24:27], v[160:175]
  v_rcp_f32 v198, v198
  v_rcp_f32 v199, v199
  v_rcp_f32 v200, v200
  v_mfma_f32_32x32x16_bf16 v[160:175], v[220:223], v[28:31], v[160:175]
  v_rcp_f32 v201, v201
  v_rcp_f32 v202, v202
  v_rcp_f32 v203, v203
  v_mfma_f32_32x32x16_bf16 v[160:175], v[224:227], v[32:35], v[160:175]
  v_rcp_f32 v204, v204
  v_rcp_f32 v205, v205
  v_mul_f32 v176, v176, v192
  v_mul_f32 v177, v177, v193
  v_mfma_f32_32x32x16_bf16 v[160:175], v[228:231], v[36:39], v[160:175]
  v_rcp_f32 v206, v206
  v_rcp_f32 v207, v207
  v_mul_f32 v178, v178, v194
  v_mul_f32 v179, v179, v195
  ds_read_b64_tr_b16 v[208:209], v1 offset:12288
  ds_read_b64_tr_b16 v[210:211], v1 offset:12544
  ds_read_b64_tr_b16 v[212:213], v1 offset:13312
  ds_read_b64_tr_b16 v[214:215], v1 offset:13568
  ds_read_b64_tr_b16 v[216:217], v1 offset:14336
  ds_read_b64_tr_b16 v[218:219], v1 offset:14592
  ds_read_b64_tr_b16 v[220:221], v1 offset:15360
  ds_read_b64_tr_b16 v[222:223], v1 offset:15616
  ds_read_b64_tr_b16 v[224:225], v1 offset:16384
  ds_read_b64_tr_b16 v[226:227], v1 offset:16640
  ds_read_b64_tr_b16 v[228:229], v1 offset:17408
  ds_read_b64_tr_b16 v[230:231], v1 offset:17664
  buffer_store_dwordx4 v[84:87], v14, s[8:11], s56 offen offset:320 sc1
  v_pk_mul_f32 v[180:181], v[180:181], v[196:197]
  v_pk_mul_f32 v[182:183], v[182:183], v[198:199]
  v_pk_mul_f32 v[184:185], v[184:185], v[200:201]
  v_pk_mul_f32 v[186:187], v[186:187], v[202:203]
  v_pk_mul_f32 v[188:189], v[188:189], v[204:205]
  v_pk_mul_f32 v[190:191], v[190:191], v[206:207]
  v_cvt_pk_bf16_f32 v176, v176, v177
  v_cvt_pk_bf16_f32 v177, v178, v179
  v_cvt_pk_bf16_f32 v178, v180, v181
  v_cvt_pk_bf16_f32 v179, v182, v183
  v_pk_fma_f32 v[192:193], v[160:161], v[160:161], s[44:45]
  v_pk_fma_f32 v[194:195], v[162:163], v[162:163], s[44:45]
  v_pk_fma_f32 v[196:197], v[164:165], v[164:165], s[44:45]
  v_pk_fma_f32 v[198:199], v[166:167], v[166:167], s[44:45]
  v_pk_fma_f32 v[200:201], v[168:169], v[168:169], s[44:45]
  v_pk_fma_f32 v[202:203], v[170:171], v[170:171], s[44:45]
  v_pk_fma_f32 v[204:205], v[172:173], v[172:173], s[44:45]
  v_pk_fma_f32 v[206:207], v[174:175], v[174:175], s[44:45]
  v_pk_mul_f32 v[192:193], v[192:193], v[160:161] neg_lo:[1,0] neg_hi:[1,0]
  v_pk_mul_f32 v[194:195], v[194:195], v[162:163] neg_lo:[1,0] neg_hi:[1,0]
  v_pk_mul_f32 v[196:197], v[196:197], v[164:165] neg_lo:[1,0] neg_hi:[1,0]
  v_pk_mul_f32 v[198:199], v[198:199], v[166:167] neg_lo:[1,0] neg_hi:[1,0]
  v_pk_mul_f32 v[200:201], v[200:201], v[168:169] neg_lo:[1,0] neg_hi:[1,0]
  v_pk_mul_f32 v[202:203], v[202:203], v[170:171] neg_lo:[1,0] neg_hi:[1,0]
  v_pk_mul_f32 v[204:205], v[204:205], v[172:173] neg_lo:[1,0] neg_hi:[1,0]
  v_pk_mul_f32 v[206:207], v[206:207], v[174:175] neg_lo:[1,0] neg_hi:[1,0]
  s_waitcnt lgkmcnt(12)
  v_mfma_f32_32x32x16_bf16 v[112:127], v[232:235], v[176:179], v[112:127]
  v_exp_f32 v192, v192
  v_exp_f32 v193, v193
  v_cvt_pk_bf16_f32 v184, v184, v185
  v_cvt_pk_bf16_f32 v185, v186, v187
  v_mfma_f32_32x32x16_bf16 v[128:143], v[236:239], v[176:179], v[128:143]
  v_exp_f32 v194, v194
  v_exp_f32 v195, v195
  v_cvt_pk_bf16_f32 v186, v188, v189
  v_cvt_pk_bf16_f32 v187, v190, v191
  v_mfma_f32_32x32x16_bf16 v[144:159], v[240:243], v[176:179], v[144:159]
  v_exp_f32 v196, v196
  v_exp_f32 v197, v197
  v_exp_f32 v198, v198
  v_mfma_f32_32x32x16_bf16 v[112:127], v[244:247], v[184:187], v[112:127]
  v_exp_f32 v199, v199
  v_exp_f32 v200, v200
  v_exp_f32 v201, v201
  v_mfma_f32_32x32x16_bf16 v[128:143], v[248:251], v[184:187], v[128:143]
  v_exp_f32 v202, v202
  v_exp_f32 v203, v203
  v_exp_f32 v204, v204
  v_mfma_f32_32x32x16_bf16 v[144:159], v[252:255], v[184:187], v[144:159]
  v_exp_f32 v205, v205
  v_exp_f32 v206, v206
  v_exp_f32 v207, v207
  s_and_b32 s30, s28, 1
  s_mul_i32 s30, s30, 73728
  s_sub_u32 s30, s30, 12288
  v_add_u32 v2, s30, v2
  ds_read_b64_tr_b16 v[232:233], v2 offset:6144
  ds_read_b64_tr_b16 v[234:235], v2 offset:6912
  ds_read_b64_tr_b16 v[236:237], v2 offset:6208
  ds_read_b64_tr_b16 v[238:239], v2 offset:6976
  ds_read_b64_tr_b16 v[240:241], v2 offset:6272
  ds_read_b64_tr_b16 v[242:243], v2 offset:7040
  ds_read_b64_tr_b16 v[244:245], v2 offset:9216
  ds_read_b64_tr_b16 v[246:247], v2 offset:9984
  ds_read_b64_tr_b16 v[248:249], v2 offset:9280
  ds_read_b64_tr_b16 v[250:251], v2 offset:10048
  ds_read_b64_tr_b16 v[252:253], v2 offset:9344
  ds_read_b64_tr_b16 v[254:255], v2 offset:10112
  v_pk_fma_f32 v[192:193], v[192:193], s[46:47], s[46:47]
  v_pk_fma_f32 v[194:195], v[194:195], s[46:47], s[46:47]
  v_pk_fma_f32 v[196:197], v[196:197], s[46:47], s[46:47]
  v_pk_fma_f32 v[198:199], v[198:199], s[46:47], s[46:47]
  v_pk_fma_f32 v[200:201], v[200:201], s[46:47], s[46:47]
  v_pk_fma_f32 v[202:203], v[202:203], s[46:47], s[46:47]
  v_pk_fma_f32 v[204:205], v[204:205], s[46:47], s[46:47]
  v_pk_fma_f32 v[206:207], v[206:207], s[46:47], s[46:47]
  s_waitcnt lgkmcnt(12)
  v_mfma_f32_32x32x16_bf16 v[176:191], v[208:211], v[16:19], 0
  v_rcp_f32 v192, v192
  v_rcp_f32 v193, v193
  v_rcp_f32 v194, v194
  v_mfma_f32_32x32x16_bf16 v[176:191], v[212:215], v[20:23], v[176:191]
  v_rcp_f32 v195, v195
  v_rcp_f32 v196, v196
  v_rcp_f32 v197, v197
  v_mfma_f32_32x32x16_bf16 v[176:191], v[216:219], v[24:27], v[176:191]
  v_rcp_f32 v198, v198
  v_rcp_f32 v199, v199
  v_rcp_f32 v200, v200
  v_mfma_f32_32x32x16_bf16 v[176:191], v[220:223], v[28:31], v[176:191]
  v_rcp_f32 v201, v201
  v_rcp_f32 v202, v202
  v_rcp_f32 v203, v203
  v_mfma_f32_32x32x16_bf16 v[176:191], v[224:227], v[32:35], v[176:191]
  v_rcp_f32 v204, v204
  v_rcp_f32 v205, v205
  v_mul_f32 v160, v160, v192
  v_mul_f32 v161, v161, v193
  v_mfma_f32_32x32x16_bf16 v[176:191], v[228:231], v[36:39], v[176:191]
  v_rcp_f32 v206, v206
  v_rcp_f32 v207, v207
  v_mul_f32 v162, v162, v194
  v_mul_f32 v163, v163, v195
  ds_read_b64_tr_b16 v[208:209], v1 offset:24576
  ds_read_b64_tr_b16 v[210:211], v1 offset:24832
  ds_read_b64_tr_b16 v[212:213], v1 offset:25600
  ds_read_b64_tr_b16 v[214:215], v1 offset:25856
  ds_read_b64_tr_b16 v[216:217], v1 offset:26624
  ds_read_b64_tr_b16 v[218:219], v1 offset:26880
  ds_read_b64_tr_b16 v[220:221], v1 offset:27648
  ds_read_b64_tr_b16 v[222:223], v1 offset:27904
  ds_read_b64_tr_b16 v[224:225], v1 offset:28672
  ds_read_b64_tr_b16 v[226:227], v1 offset:28928
  ds_read_b64_tr_b16 v[228:229], v1 offset:29696
  ds_read_b64_tr_b16 v[230:231], v1 offset:29952
  v_pk_mul_f32 v[164:165], v[164:165], v[196:197]
  v_pk_mul_f32 v[166:167], v[166:167], v[198:199]
  v_pk_mul_f32 v[168:169], v[168:169], v[200:201]
  v_pk_mul_f32 v[170:171], v[170:171], v[202:203]
  v_pk_mul_f32 v[172:173], v[172:173], v[204:205]
  v_pk_mul_f32 v[174:175], v[174:175], v[206:207]
  v_cvt_pk_bf16_f32 v160, v160, v161
  v_cvt_pk_bf16_f32 v161, v162, v163
  v_cvt_pk_bf16_f32 v162, v164, v165
  v_cvt_pk_bf16_f32 v163, v166, v167
  v_pk_fma_f32 v[192:193], v[176:177], v[176:177], s[44:45]
  v_pk_fma_f32 v[194:195], v[178:179], v[178:179], s[44:45]
  v_pk_fma_f32 v[196:197], v[180:181], v[180:181], s[44:45]
  v_pk_fma_f32 v[198:199], v[182:183], v[182:183], s[44:45]
  v_pk_fma_f32 v[200:201], v[184:185], v[184:185], s[44:45]
  v_pk_fma_f32 v[202:203], v[186:187], v[186:187], s[44:45]
  v_pk_fma_f32 v[204:205], v[188:189], v[188:189], s[44:45]
  v_pk_fma_f32 v[206:207], v[190:191], v[190:191], s[44:45]
  v_pk_mul_f32 v[192:193], v[192:193], v[176:177] neg_lo:[1,0] neg_hi:[1,0]
  v_pk_mul_f32 v[194:195], v[194:195], v[178:179] neg_lo:[1,0] neg_hi:[1,0]
  v_pk_mul_f32 v[196:197], v[196:197], v[180:181] neg_lo:[1,0] neg_hi:[1,0]
  v_pk_mul_f32 v[198:199], v[198:199], v[182:183] neg_lo:[1,0] neg_hi:[1,0]
  v_pk_mul_f32 v[200:201], v[200:201], v[184:185] neg_lo:[1,0] neg_hi:[1,0]
  v_pk_mul_f32 v[202:203], v[202:203], v[186:187] neg_lo:[1,0] neg_hi:[1,0]
  v_pk_mul_f32 v[204:205], v[204:205], v[188:189] neg_lo:[1,0] neg_hi:[1,0]
  v_pk_mul_f32 v[206:207], v[206:207], v[190:191] neg_lo:[1,0] neg_hi:[1,0]
  v_cvt_pk_bf16_f32 v112, v112, v113
  v_cvt_pk_bf16_f32 v113, v114, v115
  v_cvt_pk_bf16_f32 v114, v116, v117
  v_cvt_pk_bf16_f32 v115, v118, v119
  v_cvt_pk_bf16_f32 v116, v120, v121
  v_cvt_pk_bf16_f32 v117, v122, v123
  v_cvt_pk_bf16_f32 v118, v124, v125
  v_cvt_pk_bf16_f32 v119, v126, v127
  v_cvt_pk_bf16_f32 v120, v128, v129
  v_cvt_pk_bf16_f32 v121, v130, v131
  v_cvt_pk_bf16_f32 v122, v132, v133
  v_cvt_pk_bf16_f32 v123, v134, v135
  v_cvt_pk_bf16_f32 v124, v136, v137
  v_cvt_pk_bf16_f32 v125, v138, v139
  v_cvt_pk_bf16_f32 v126, v140, v141
  v_cvt_pk_bf16_f32 v127, v142, v143
  v_cvt_pk_bf16_f32 v128, v144, v145
  v_cvt_pk_bf16_f32 v129, v146, v147
  v_cvt_pk_bf16_f32 v130, v148, v149
  v_cvt_pk_bf16_f32 v131, v150, v151
  v_cvt_pk_bf16_f32 v132, v152, v153
  v_cvt_pk_bf16_f32 v133, v154, v155
  v_cvt_pk_bf16_f32 v134, v156, v157
  v_cvt_pk_bf16_f32 v135, v158, v159
  v_permlane16_swap_b32 v112, v116
  v_permlane16_swap_b32 v113, v117
  v_permlane16_swap_b32 v114, v118
  v_permlane16_swap_b32 v115, v119
  v_permlane16_swap_b32 v120, v124
  v_permlane16_swap_b32 v121, v125
  v_permlane16_swap_b32 v122, v126
  v_permlane16_swap_b32 v123, v127
  v_permlane16_swap_b32 v128, v132
  v_permlane16_swap_b32 v129, v133
  v_permlane16_swap_b32 v130, v134
  v_permlane16_swap_b32 v131, v135
  s_waitcnt lgkmcnt(12)
  v_mfma_f32_32x32x16_bf16 v[64:79], v[232:235], v[160:163], 0
  v_exp_f32 v192, v192
  v_exp_f32 v193, v193
  v_cvt_pk_bf16_f32 v168, v168, v169
  v_cvt_pk_bf16_f32 v169, v170, v171
  v_mfma_f32_32x32x16_bf16 v[80:95], v[236:239], v[160:163], 0
  v_exp_f32 v194, v194
  v_exp_f32 v195, v195
  v_cvt_pk_bf16_f32 v170, v172, v173
  v_cvt_pk_bf16_f32 v171, v174, v175
  v_mfma_f32_32x32x16_bf16 v[96:111], v[240:243], v[160:163], 0
  v_exp_f32 v196, v196
  v_exp_f32 v197, v197
  v_exp_f32 v198, v198
  v_mfma_f32_32x32x16_bf16 v[64:79], v[244:247], v[168:171], v[64:79]
  v_exp_f32 v199, v199
  v_exp_f32 v200, v200
  v_exp_f32 v201, v201
  v_mfma_f32_32x32x16_bf16 v[80:95], v[248:251], v[168:171], v[80:95]
  v_exp_f32 v202, v202
  v_exp_f32 v203, v203
  v_exp_f32 v204, v204
  v_mfma_f32_32x32x16_bf16 v[96:111], v[252:255], v[168:171], v[96:111]
  v_exp_f32 v205, v205
  v_exp_f32 v206, v206
  v_exp_f32 v207, v207
  ds_read_b64_tr_b16 v[232:233], v2 offset:18432
  ds_read_b64_tr_b16 v[234:235], v2 offset:19200
  ds_read_b64_tr_b16 v[236:237], v2 offset:18496
  ds_read_b64_tr_b16 v[238:239], v2 offset:19264
  ds_read_b64_tr_b16 v[240:241], v2 offset:18560
  ds_read_b64_tr_b16 v[242:243], v2 offset:19328
  ds_read_b64_tr_b16 v[244:245], v2 offset:21504
  ds_read_b64_tr_b16 v[246:247], v2 offset:22272
  ds_read_b64_tr_b16 v[248:249], v2 offset:21568
  ds_read_b64_tr_b16 v[250:251], v2 offset:22336
  ds_read_b64_tr_b16 v[252:253], v2 offset:21632
  ds_read_b64_tr_b16 v[254:255], v2 offset:22400
  buffer_load_dwordx4 v[136:139], v9, s[4:7], s50 offen offset:0
  buffer_load_dwordx4 v[140:143], v9, s[4:7], s50 offen offset:32
  v_pk_fma_f32 v[192:193], v[192:193], s[46:47], s[46:47]
  v_pk_fma_f32 v[194:195], v[194:195], s[46:47], s[46:47]
  v_pk_fma_f32 v[196:197], v[196:197], s[46:47], s[46:47]
  v_pk_fma_f32 v[198:199], v[198:199], s[46:47], s[46:47]
  v_pk_fma_f32 v[200:201], v[200:201], s[46:47], s[46:47]
  v_pk_fma_f32 v[202:203], v[202:203], s[46:47], s[46:47]
  v_pk_fma_f32 v[204:205], v[204:205], s[46:47], s[46:47]
  v_pk_fma_f32 v[206:207], v[206:207], s[46:47], s[46:47]
  s_waitcnt lgkmcnt(12)
  v_mfma_f32_32x32x16_bf16 v[160:175], v[208:211], v[16:19], 0
  v_rcp_f32 v192, v192
  v_rcp_f32 v193, v193
  v_rcp_f32 v194, v194
  v_mfma_f32_32x32x16_bf16 v[160:175], v[212:215], v[20:23], v[160:175]
  v_rcp_f32 v195, v195
  v_rcp_f32 v196, v196
  v_rcp_f32 v197, v197
  v_mfma_f32_32x32x16_bf16 v[160:175], v[216:219], v[24:27], v[160:175]
  v_rcp_f32 v198, v198
  v_rcp_f32 v199, v199
  v_rcp_f32 v200, v200
  v_mfma_f32_32x32x16_bf16 v[160:175], v[220:223], v[28:31], v[160:175]
  v_rcp_f32 v201, v201
  v_rcp_f32 v202, v202
  v_rcp_f32 v203, v203
  v_mfma_f32_32x32x16_bf16 v[160:175], v[224:227], v[32:35], v[160:175]
  v_rcp_f32 v204, v204
  v_rcp_f32 v205, v205
  v_mul_f32 v176, v176, v192
  v_mul_f32 v177, v177, v193
  v_mfma_f32_32x32x16_bf16 v[160:175], v[228:231], v[36:39], v[160:175]
  v_rcp_f32 v206, v206
  v_rcp_f32 v207, v207
  v_mul_f32 v178, v178, v194
  v_mul_f32 v179, v179, v195
  ds_read_b64_tr_b16 v[208:209], v1 offset:36864
  ds_read_b64_tr_b16 v[210:211], v1 offset:37120
  ds_read_b64_tr_b16 v[212:213], v1 offset:37888
  ds_read_b64_tr_b16 v[214:215], v1 offset:38144
  ds_read_b64_tr_b16 v[216:217], v1 offset:38912
  ds_read_b64_tr_b16 v[218:219], v1 offset:39168
  ds_read_b64_tr_b16 v[220:221], v1 offset:39936
  ds_read_b64_tr_b16 v[222:223], v1 offset:40192
  ds_read_b64_tr_b16 v[224:225], v1 offset:40960
  ds_read_b64_tr_b16 v[226:227], v1 offset:41216
  ds_read_b64_tr_b16 v[228:229], v1 offset:41984
  ds_read_b64_tr_b16 v[230:231], v1 offset:42240
  buffer_load_dwordx4 v[144:147], v9, s[4:7], s50 offen offset:64
  buffer_load_dwordx4 v[148:151], v9, s[4:7], s50 offen offset:96
  v_pk_mul_f32 v[180:181], v[180:181], v[196:197]
  v_pk_mul_f32 v[182:183], v[182:183], v[198:199]
  v_pk_mul_f32 v[184:185], v[184:185], v[200:201]
  v_pk_mul_f32 v[186:187], v[186:187], v[202:203]
  v_pk_mul_f32 v[188:189], v[188:189], v[204:205]
  v_pk_mul_f32 v[190:191], v[190:191], v[206:207]
  v_cvt_pk_bf16_f32 v176, v176, v177
  v_cvt_pk_bf16_f32 v177, v178, v179
  v_cvt_pk_bf16_f32 v178, v180, v181
  v_cvt_pk_bf16_f32 v179, v182, v183
  v_pk_fma_f32 v[192:193], v[160:161], v[160:161], s[44:45]
  v_pk_fma_f32 v[194:195], v[162:163], v[162:163], s[44:45]
  v_pk_fma_f32 v[196:197], v[164:165], v[164:165], s[44:45]
  v_pk_fma_f32 v[198:199], v[166:167], v[166:167], s[44:45]
  v_pk_fma_f32 v[200:201], v[168:169], v[168:169], s[44:45]
  v_pk_fma_f32 v[202:203], v[170:171], v[170:171], s[44:45]
  v_pk_fma_f32 v[204:205], v[172:173], v[172:173], s[44:45]
  v_pk_fma_f32 v[206:207], v[174:175], v[174:175], s[44:45]
  v_pk_mul_f32 v[192:193], v[192:193], v[160:161] neg_lo:[1,0] neg_hi:[1,0]
  v_pk_mul_f32 v[194:195], v[194:195], v[162:163] neg_lo:[1,0] neg_hi:[1,0]
  v_pk_mul_f32 v[196:197], v[196:197], v[164:165] neg_lo:[1,0] neg_hi:[1,0]
  v_pk_mul_f32 v[198:199], v[198:199], v[166:167] neg_lo:[1,0] neg_hi:[1,0]
  v_pk_mul_f32 v[200:201], v[200:201], v[168:169] neg_lo:[1,0] neg_hi:[1,0]
  v_pk_mul_f32 v[202:203], v[202:203], v[170:171] neg_lo:[1,0] neg_hi:[1,0]
  v_pk_mul_f32 v[204:205], v[204:205], v[172:173] neg_lo:[1,0] neg_hi:[1,0]
  v_pk_mul_f32 v[206:207], v[206:207], v[174:175] neg_lo:[1,0] neg_hi:[1,0]
  s_waitcnt lgkmcnt(12)
  v_mfma_f32_32x32x16_bf16 v[64:79], v[232:235], v[176:179], v[64:79]
  v_exp_f32 v192, v192
  v_exp_f32 v193, v193
  v_cvt_pk_bf16_f32 v184, v184, v185
  v_cvt_pk_bf16_f32 v185, v186, v187
  v_mfma_f32_32x32x16_bf16 v[80:95], v[236:239], v[176:179], v[80:95]
  v_exp_f32 v194, v194
  v_exp_f32 v195, v195
  v_cvt_pk_bf16_f32 v186, v188, v189
  v_cvt_pk_bf16_f32 v187, v190, v191
  v_mfma_f32_32x32x16_bf16 v[96:111], v[240:243], v[176:179], v[96:111]
  v_exp_f32 v196, v196
  v_exp_f32 v197, v197
  v_exp_f32 v198, v198
  v_mfma_f32_32x32x16_bf16 v[64:79], v[244:247], v[184:187], v[64:79]
  v_exp_f32 v199, v199
  v_exp_f32 v200, v200
  v_exp_f32 v201, v201
  v_mfma_f32_32x32x16_bf16 v[80:95], v[248:251], v[184:187], v[80:95]
  v_exp_f32 v202, v202
  v_exp_f32 v203, v203
  v_exp_f32 v204, v204
  v_mfma_f32_32x32x16_bf16 v[96:111], v[252:255], v[184:187], v[96:111]
  v_exp_f32 v205, v205
  v_exp_f32 v206, v206
  v_exp_f32 v207, v207
  ds_read_b64_tr_b16 v[232:233], v2 offset:30720
  ds_read_b64_tr_b16 v[234:235], v2 offset:31488
  ds_read_b64_tr_b16 v[236:237], v2 offset:30784
  ds_read_b64_tr_b16 v[238:239], v2 offset:31552
  ds_read_b64_tr_b16 v[240:241], v2 offset:30848
  ds_read_b64_tr_b16 v[242:243], v2 offset:31616
  ds_read_b64_tr_b16 v[244:245], v2 offset:33792
  ds_read_b64_tr_b16 v[246:247], v2 offset:34560
  ds_read_b64_tr_b16 v[248:249], v2 offset:33856
  ds_read_b64_tr_b16 v[250:251], v2 offset:34624
  ds_read_b64_tr_b16 v[252:253], v2 offset:33920
  ds_read_b64_tr_b16 v[254:255], v2 offset:34688
  buffer_store_dwordx4 v[112:115], v14, s[8:11], s57 offen offset:0 sc1
  v_pk_fma_f32 v[192:193], v[192:193], s[46:47], s[46:47]
  v_pk_fma_f32 v[194:195], v[194:195], s[46:47], s[46:47]
  v_pk_fma_f32 v[196:197], v[196:197], s[46:47], s[46:47]
  v_pk_fma_f32 v[198:199], v[198:199], s[46:47], s[46:47]
  v_pk_fma_f32 v[200:201], v[200:201], s[46:47], s[46:47]
  v_pk_fma_f32 v[202:203], v[202:203], s[46:47], s[46:47]
  v_pk_fma_f32 v[204:205], v[204:205], s[46:47], s[46:47]
  v_pk_fma_f32 v[206:207], v[206:207], s[46:47], s[46:47]
  s_waitcnt lgkmcnt(12)
  v_mfma_f32_32x32x16_bf16 v[176:191], v[208:211], v[16:19], 0
  v_rcp_f32 v192, v192
  v_rcp_f32 v193, v193
  v_rcp_f32 v194, v194
  v_mfma_f32_32x32x16_bf16 v[176:191], v[212:215], v[20:23], v[176:191]
  v_rcp_f32 v195, v195
  v_rcp_f32 v196, v196
  v_rcp_f32 v197, v197
  v_mfma_f32_32x32x16_bf16 v[176:191], v[216:219], v[24:27], v[176:191]
  v_rcp_f32 v198, v198
  v_rcp_f32 v199, v199
  v_rcp_f32 v200, v200
  v_mfma_f32_32x32x16_bf16 v[176:191], v[220:223], v[28:31], v[176:191]
  v_rcp_f32 v201, v201
  v_rcp_f32 v202, v202
  v_rcp_f32 v203, v203
  v_mfma_f32_32x32x16_bf16 v[176:191], v[224:227], v[32:35], v[176:191]
  v_rcp_f32 v204, v204
  v_rcp_f32 v205, v205
  v_mul_f32 v160, v160, v192
  v_mul_f32 v161, v161, v193
  v_mfma_f32_32x32x16_bf16 v[176:191], v[228:231], v[36:39], v[176:191]
  v_rcp_f32 v206, v206
  v_rcp_f32 v207, v207
  v_mul_f32 v162, v162, v194
  v_mul_f32 v163, v163, v195
  ds_read_b64_tr_b16 v[208:209], v1 offset:49152
  ds_read_b64_tr_b16 v[210:211], v1 offset:49408
  ds_read_b64_tr_b16 v[212:213], v1 offset:50176
  ds_read_b64_tr_b16 v[214:215], v1 offset:50432
  ds_read_b64_tr_b16 v[216:217], v1 offset:51200
  ds_read_b64_tr_b16 v[218:219], v1 offset:51456
  ds_read_b64_tr_b16 v[220:221], v1 offset:52224
  ds_read_b64_tr_b16 v[222:223], v1 offset:52480
  ds_read_b64_tr_b16 v[224:225], v1 offset:53248
  ds_read_b64_tr_b16 v[226:227], v1 offset:53504
  ds_read_b64_tr_b16 v[228:229], v1 offset:54272
  ds_read_b64_tr_b16 v[230:231], v1 offset:54528
  buffer_store_dwordx4 v[116:119], v14, s[8:11], s57 offen offset:192 sc1
  v_pk_mul_f32 v[164:165], v[164:165], v[196:197]
  v_pk_mul_f32 v[166:167], v[166:167], v[198:199]
  v_pk_mul_f32 v[168:169], v[168:169], v[200:201]
  v_pk_mul_f32 v[170:171], v[170:171], v[202:203]
  v_pk_mul_f32 v[172:173], v[172:173], v[204:205]
  v_pk_mul_f32 v[174:175], v[174:175], v[206:207]
  v_cvt_pk_bf16_f32 v160, v160, v161
  v_cvt_pk_bf16_f32 v161, v162, v163
  v_cvt_pk_bf16_f32 v162, v164, v165
  v_cvt_pk_bf16_f32 v163, v166, v167
  v_pk_fma_f32 v[192:193], v[176:177], v[176:177], s[44:45]
  v_pk_fma_f32 v[194:195], v[178:179], v[178:179], s[44:45]
  v_pk_fma_f32 v[196:197], v[180:181], v[180:181], s[44:45]
  v_pk_fma_f32 v[198:199], v[182:183], v[182:183], s[44:45]
  v_pk_fma_f32 v[200:201], v[184:185], v[184:185], s[44:45]
  v_pk_fma_f32 v[202:203], v[186:187], v[186:187], s[44:45]
  v_pk_fma_f32 v[204:205], v[188:189], v[188:189], s[44:45]
  v_pk_fma_f32 v[206:207], v[190:191], v[190:191], s[44:45]
  v_pk_mul_f32 v[192:193], v[192:193], v[176:177] neg_lo:[1,0] neg_hi:[1,0]
  v_pk_mul_f32 v[194:195], v[194:195], v[178:179] neg_lo:[1,0] neg_hi:[1,0]
  v_pk_mul_f32 v[196:197], v[196:197], v[180:181] neg_lo:[1,0] neg_hi:[1,0]
  v_pk_mul_f32 v[198:199], v[198:199], v[182:183] neg_lo:[1,0] neg_hi:[1,0]
  v_pk_mul_f32 v[200:201], v[200:201], v[184:185] neg_lo:[1,0] neg_hi:[1,0]
  v_pk_mul_f32 v[202:203], v[202:203], v[186:187] neg_lo:[1,0] neg_hi:[1,0]
  v_pk_mul_f32 v[204:205], v[204:205], v[188:189] neg_lo:[1,0] neg_hi:[1,0]
  v_pk_mul_f32 v[206:207], v[206:207], v[190:191] neg_lo:[1,0] neg_hi:[1,0]
  s_waitcnt lgkmcnt(12)
  v_mfma_f32_32x32x16_bf16 v[64:79], v[232:235], v[160:163], v[64:79]
  v_exp_f32 v192, v192
  v_exp_f32 v193, v193
  v_cvt_pk_bf16_f32 v168, v168, v169
  v_cvt_pk_bf16_f32 v169, v170, v171
  v_mfma_f32_32x32x16_bf16 v[80:95], v[236:239], v[160:163], v[80:95]
  v_exp_f32 v194, v194
  v_exp_f32 v195, v195
  v_cvt_pk_bf16_f32 v170, v172, v173
  v_cvt_pk_bf16_f32 v171, v174, v175
  v_mfma_f32_32x32x16_bf16 v[96:111], v[240:243], v[160:163], v[96:111]
  v_exp_f32 v196, v196
  v_exp_f32 v197, v197
  v_exp_f32 v198, v198
  v_mfma_f32_32x32x16_bf16 v[64:79], v[244:247], v[168:171], v[64:79]
  v_exp_f32 v199, v199
  v_exp_f32 v200, v200
  v_exp_f32 v201, v201
  v_mfma_f32_32x32x16_bf16 v[80:95], v[248:251], v[168:171], v[80:95]
  v_exp_f32 v202, v202
  v_exp_f32 v203, v203
  v_exp_f32 v204, v204
  v_mfma_f32_32x32x16_bf16 v[96:111], v[252:255], v[168:171], v[96:111]
  v_exp_f32 v205, v205
  v_exp_f32 v206, v206
  v_exp_f32 v207, v207
  ds_read_b64_tr_b16 v[232:233], v2 offset:43008
  ds_read_b64_tr_b16 v[234:235], v2 offset:43776
  ds_read_b64_tr_b16 v[236:237], v2 offset:43072
  ds_read_b64_tr_b16 v[238:239], v2 offset:43840
  ds_read_b64_tr_b16 v[240:241], v2 offset:43136
  ds_read_b64_tr_b16 v[242:243], v2 offset:43904
  ds_read_b64_tr_b16 v[244:245], v2 offset:46080
  ds_read_b64_tr_b16 v[246:247], v2 offset:46848
  ds_read_b64_tr_b16 v[248:249], v2 offset:46144
  ds_read_b64_tr_b16 v[250:251], v2 offset:46912
  ds_read_b64_tr_b16 v[252:253], v2 offset:46208
  ds_read_b64_tr_b16 v[254:255], v2 offset:46976
  buffer_store_dwordx4 v[120:123], v14, s[8:11], s57 offen offset:64 sc1
  v_pk_fma_f32 v[192:193], v[192:193], s[46:47], s[46:47]
  v_pk_fma_f32 v[194:195], v[194:195], s[46:47], s[46:47]
  v_pk_fma_f32 v[196:197], v[196:197], s[46:47], s[46:47]
  v_pk_fma_f32 v[198:199], v[198:199], s[46:47], s[46:47]
  v_pk_fma_f32 v[200:201], v[200:201], s[46:47], s[46:47]
  v_pk_fma_f32 v[202:203], v[202:203], s[46:47], s[46:47]
  v_pk_fma_f32 v[204:205], v[204:205], s[46:47], s[46:47]
  v_pk_fma_f32 v[206:207], v[206:207], s[46:47], s[46:47]
  s_waitcnt lgkmcnt(12)
  v_mfma_f32_32x32x16_bf16 v[160:175], v[208:211], v[16:19], 0
  v_rcp_f32 v192, v192
  v_rcp_f32 v193, v193
  v_rcp_f32 v194, v194
  v_mfma_f32_32x32x16_bf16 v[160:175], v[212:215], v[20:23], v[160:175]
  v_rcp_f32 v195, v195
  v_rcp_f32 v196, v196
  v_rcp_f32 v197, v197
  v_mfma_f32_32x32x16_bf16 v[160:175], v[216:219], v[24:27], v[160:175]
  v_rcp_f32 v198, v198
  v_rcp_f32 v199, v199
  v_rcp_f32 v200, v200
  v_mfma_f32_32x32x16_bf16 v[160:175], v[220:223], v[28:31], v[160:175]
  v_rcp_f32 v201, v201
  v_rcp_f32 v202, v202
  v_rcp_f32 v203, v203
  v_mfma_f32_32x32x16_bf16 v[160:175], v[224:227], v[32:35], v[160:175]
  v_rcp_f32 v204, v204
  v_rcp_f32 v205, v205
  v_mul_f32 v176, v176, v192
  v_mul_f32 v177, v177, v193
  v_mfma_f32_32x32x16_bf16 v[160:175], v[228:231], v[36:39], v[160:175]
  v_rcp_f32 v206, v206
  v_rcp_f32 v207, v207
  v_mul_f32 v178, v178, v194
  v_mul_f32 v179, v179, v195
  v_add_u32 v1, 61440, v1
  ds_read_b64_tr_b16 v[208:209], v1 offset:0
  ds_read_b64_tr_b16 v[210:211], v1 offset:256
  ds_read_b64_tr_b16 v[212:213], v1 offset:1024
  ds_read_b64_tr_b16 v[214:215], v1 offset:1280
  ds_read_b64_tr_b16 v[216:217], v1 offset:2048
  ds_read_b64_tr_b16 v[218:219], v1 offset:2304
  ds_read_b64_tr_b16 v[220:221], v1 offset:3072
  ds_read_b64_tr_b16 v[222:223], v1 offset:3328
  ds_read_b64_tr_b16 v[224:225], v1 offset:4096
  ds_read_b64_tr_b16 v[226:227], v1 offset:4352
  ds_read_b64_tr_b16 v[228:229], v1 offset:5120
  ds_read_b64_tr_b16 v[230:231], v1 offset:5376
  buffer_store_dwordx4 v[124:127], v14, s[8:11], s57 offen offset:256 sc1
  v_pk_mul_f32 v[180:181], v[180:181], v[196:197]
  v_pk_mul_f32 v[182:183], v[182:183], v[198:199]
  v_pk_mul_f32 v[184:185], v[184:185], v[200:201]
  v_pk_mul_f32 v[186:187], v[186:187], v[202:203]
  v_pk_mul_f32 v[188:189], v[188:189], v[204:205]
  v_pk_mul_f32 v[190:191], v[190:191], v[206:207]
  v_cvt_pk_bf16_f32 v176, v176, v177
  v_cvt_pk_bf16_f32 v177, v178, v179
  v_cvt_pk_bf16_f32 v178, v180, v181
  v_cvt_pk_bf16_f32 v179, v182, v183
  v_pk_fma_f32 v[192:193], v[160:161], v[160:161], s[44:45]
  v_pk_fma_f32 v[194:195], v[162:163], v[162:163], s[44:45]
  v_pk_fma_f32 v[196:197], v[164:165], v[164:165], s[44:45]
  v_pk_fma_f32 v[198:199], v[166:167], v[166:167], s[44:45]
  v_pk_fma_f32 v[200:201], v[168:169], v[168:169], s[44:45]
  v_pk_fma_f32 v[202:203], v[170:171], v[170:171], s[44:45]
  v_pk_fma_f32 v[204:205], v[172:173], v[172:173], s[44:45]
  v_pk_fma_f32 v[206:207], v[174:175], v[174:175], s[44:45]
  v_pk_mul_f32 v[192:193], v[192:193], v[160:161] neg_lo:[1,0] neg_hi:[1,0]
  v_pk_mul_f32 v[194:195], v[194:195], v[162:163] neg_lo:[1,0] neg_hi:[1,0]
  v_pk_mul_f32 v[196:197], v[196:197], v[164:165] neg_lo:[1,0] neg_hi:[1,0]
  v_pk_mul_f32 v[198:199], v[198:199], v[166:167] neg_lo:[1,0] neg_hi:[1,0]
  v_pk_mul_f32 v[200:201], v[200:201], v[168:169] neg_lo:[1,0] neg_hi:[1,0]
  v_pk_mul_f32 v[202:203], v[202:203], v[170:171] neg_lo:[1,0] neg_hi:[1,0]
  v_pk_mul_f32 v[204:205], v[204:205], v[172:173] neg_lo:[1,0] neg_hi:[1,0]
  v_pk_mul_f32 v[206:207], v[206:207], v[174:175] neg_lo:[1,0] neg_hi:[1,0]
  s_waitcnt lgkmcnt(12)
  v_mfma_f32_32x32x16_bf16 v[64:79], v[232:235], v[176:179], v[64:79]
  v_exp_f32 v192, v192
  v_exp_f32 v193, v193
  v_cvt_pk_bf16_f32 v184, v184, v185
  v_cvt_pk_bf16_f32 v185, v186, v187
  v_mfma_f32_32x32x16_bf16 v[80:95], v[236:239], v[176:179], v[80:95]
  v_exp_f32 v194, v194
  v_exp_f32 v195, v195
  v_cvt_pk_bf16_f32 v186, v188, v189
  v_cvt_pk_bf16_f32 v187, v190, v191
  v_mfma_f32_32x32x16_bf16 v[96:111], v[240:243], v[176:179], v[96:111]
  v_exp_f32 v196, v196
  v_exp_f32 v197, v197
  v_exp_f32 v198, v198
  v_mfma_f32_32x32x16_bf16 v[64:79], v[244:247], v[184:187], v[64:79]
  v_exp_f32 v199, v199
  v_exp_f32 v200, v200
  v_exp_f32 v201, v201
  v_mfma_f32_32x32x16_bf16 v[80:95], v[248:251], v[184:187], v[80:95]
  v_exp_f32 v202, v202
  v_exp_f32 v203, v203
  v_exp_f32 v204, v204
  v_mfma_f32_32x32x16_bf16 v[96:111], v[252:255], v[184:187], v[96:111]
  v_exp_f32 v205, v205
  v_exp_f32 v206, v206
  v_exp_f32 v207, v207
  ds_read_b64_tr_b16 v[232:233], v2 offset:55296
  ds_read_b64_tr_b16 v[234:235], v2 offset:56064
  ds_read_b64_tr_b16 v[236:237], v2 offset:55360
  ds_read_b64_tr_b16 v[238:239], v2 offset:56128
  ds_read_b64_tr_b16 v[240:241], v2 offset:55424
  ds_read_b64_tr_b16 v[242:243], v2 offset:56192
  ds_read_b64_tr_b16 v[244:245], v2 offset:58368
  ds_read_b64_tr_b16 v[246:247], v2 offset:59136
  ds_read_b64_tr_b16 v[248:249], v2 offset:58432
  ds_read_b64_tr_b16 v[250:251], v2 offset:59200
  ds_read_b64_tr_b16 v[252:253], v2 offset:58496
  ds_read_b64_tr_b16 v[254:255], v2 offset:59264
  buffer_store_dwordx4 v[128:131], v14, s[8:11], s57 offen offset:128 sc1
  v_pk_fma_f32 v[192:193], v[192:193], s[46:47], s[46:47]
  v_pk_fma_f32 v[194:195], v[194:195], s[46:47], s[46:47]
  v_pk_fma_f32 v[196:197], v[196:197], s[46:47], s[46:47]
  v_pk_fma_f32 v[198:199], v[198:199], s[46:47], s[46:47]
  v_pk_fma_f32 v[200:201], v[200:201], s[46:47], s[46:47]
  v_pk_fma_f32 v[202:203], v[202:203], s[46:47], s[46:47]
  v_pk_fma_f32 v[204:205], v[204:205], s[46:47], s[46:47]
  v_pk_fma_f32 v[206:207], v[206:207], s[46:47], s[46:47]
  s_waitcnt lgkmcnt(12)
  v_mfma_f32_32x32x16_bf16 v[176:191], v[208:211], v[16:19], 0
  v_rcp_f32 v192, v192
  v_rcp_f32 v193, v193
  v_rcp_f32 v194, v194
  v_mfma_f32_32x32x16_bf16 v[176:191], v[212:215], v[20:23], v[176:191]
  v_rcp_f32 v195, v195
  v_rcp_f32 v196, v196
  v_rcp_f32 v197, v197
  v_mfma_f32_32x32x16_bf16 v[176:191], v[216:219], v[24:27], v[176:191]
  v_rcp_f32 v198, v198
  v_rcp_f32 v199, v199
  v_rcp_f32 v200, v200
  v_mfma_f32_32x32x16_bf16 v[176:191], v[220:223], v[28:31], v[176:191]
  v_rcp_f32 v201, v201
  v_rcp_f32 v202, v202
  v_rcp_f32 v203, v203
  v_mfma_f32_32x32x16_bf16 v[176:191], v[224:227], v[32:35], v[176:191]
  v_rcp_f32 v204, v204
  v_rcp_f32 v205, v205
  v_mul_f32 v160, v160, v192
  v_mul_f32 v161, v161, v193
  v_mfma_f32_32x32x16_bf16 v[176:191], v[228:231], v[36:39], v[176:191]
  v_rcp_f32 v206, v206
  v_rcp_f32 v207, v207
  v_mul_f32 v162, v162, v194
  v_mul_f32 v163, v163, v195
  v_mul_f32 v164, v164, v196
  v_mul_f32 v165, v165, v197
  buffer_store_dwordx4 v[132:135], v14, s[8:11], s57 offen offset:320 sc1
  v_pk_mul_f32 v[166:167], v[166:167], v[198:199]
  v_pk_mul_f32 v[168:169], v[168:169], v[200:201]
  v_pk_mul_f32 v[170:171], v[170:171], v[202:203]
  v_pk_mul_f32 v[172:173], v[172:173], v[204:205]
  v_pk_mul_f32 v[174:175], v[174:175], v[206:207]
  v_cvt_pk_bf16_f32 v160, v160, v161
  v_cvt_pk_bf16_f32 v161, v162, v163
  v_cvt_pk_bf16_f32 v162, v164, v165
  v_cvt_pk_bf16_f32 v163, v166, v167
  v_pk_fma_f32 v[192:193], v[176:177], v[176:177], s[44:45]
  v_pk_fma_f32 v[194:195], v[178:179], v[178:179], s[44:45]
  v_pk_fma_f32 v[196:197], v[180:181], v[180:181], s[44:45]
  v_pk_fma_f32 v[198:199], v[182:183], v[182:183], s[44:45]
  v_pk_fma_f32 v[200:201], v[184:185], v[184:185], s[44:45]
  v_pk_fma_f32 v[202:203], v[186:187], v[186:187], s[44:45]
  v_pk_fma_f32 v[204:205], v[188:189], v[188:189], s[44:45]
  v_pk_fma_f32 v[206:207], v[190:191], v[190:191], s[44:45]
  v_pk_mul_f32 v[192:193], v[192:193], v[176:177] neg_lo:[1,0] neg_hi:[1,0]
  v_pk_mul_f32 v[194:195], v[194:195], v[178:179] neg_lo:[1,0] neg_hi:[1,0]
  v_pk_mul_f32 v[196:197], v[196:197], v[180:181] neg_lo:[1,0] neg_hi:[1,0]
  v_pk_mul_f32 v[198:199], v[198:199], v[182:183] neg_lo:[1,0] neg_hi:[1,0]
  v_pk_mul_f32 v[200:201], v[200:201], v[184:185] neg_lo:[1,0] neg_hi:[1,0]
  v_pk_mul_f32 v[202:203], v[202:203], v[186:187] neg_lo:[1,0] neg_hi:[1,0]
  v_pk_mul_f32 v[204:205], v[204:205], v[188:189] neg_lo:[1,0] neg_hi:[1,0]
  v_pk_mul_f32 v[206:207], v[206:207], v[190:191] neg_lo:[1,0] neg_hi:[1,0]
  s_mul_i32 s30, s19, 8192
  v_add_u32 v5, s30, v4
  v_xor_b32 v6, 8192, v5
  s_waitcnt vmcnt(6)
  v_lshlrev_b32 v32, 16, v136
  v_and_b32 v33, 0xffff0000, v136
  v_lshlrev_b32 v34, 16, v137
  v_and_b32 v35, 0xffff0000, v137
  v_lshlrev_b32 v36, 16, v138
  v_and_b32 v37, 0xffff0000, v138
  v_lshlrev_b32 v38, 16, v139
  v_and_b32 v39, 0xffff0000, v139
  v_lshlrev_b32 v40, 16, v140
  v_and_b32 v41, 0xffff0000, v140
  v_lshlrev_b32 v42, 16, v141
  v_and_b32 v43, 0xffff0000, v141
  v_lshlrev_b32 v44, 16, v142
  v_and_b32 v45, 0xffff0000, v142
  v_lshlrev_b32 v46, 16, v143
  v_and_b32 v47, 0xffff0000, v143
  v_lshlrev_b32 v48, 16, v144
  v_and_b32 v49, 0xffff0000, v144
  v_lshlrev_b32 v50, 16, v145
  v_and_b32 v51, 0xffff0000, v145
  v_lshlrev_b32 v52, 16, v146
  v_and_b32 v53, 0xffff0000, v146
  v_lshlrev_b32 v54, 16, v147
  v_and_b32 v55, 0xffff0000, v147
  v_lshlrev_b32 v56, 16, v148
  v_and_b32 v57, 0xffff0000, v148
  v_lshlrev_b32 v58, 16, v149
  v_and_b32 v59, 0xffff0000, v149
  v_lshlrev_b32 v60, 16, v150
  v_and_b32 v61, 0xffff0000, v150
  v_lshlrev_b32 v62, 16, v151
  v_and_b32 v63, 0xffff0000, v151
  s_barrier
  s_waitcnt lgkmcnt(0)
  v_mfma_f32_32x32x16_bf16 v[64:79], v[232:235], v[160:163], v[64:79]
  v_exp_f32 v192, v192
  v_exp_f32 v193, v193
  v_cvt_pk_bf16_f32 v168, v168, v169
  v_cvt_pk_bf16_f32 v169, v170, v171
  v_mfma_f32_32x32x16_bf16 v[80:95], v[236:239], v[160:163], v[80:95]
  v_exp_f32 v194, v194
  v_exp_f32 v195, v195
  v_cvt_pk_bf16_f32 v170, v172, v173
  v_cvt_pk_bf16_f32 v171, v174, v175
  v_mfma_f32_32x32x16_bf16 v[96:111], v[240:243], v[160:163], v[96:111]
  v_exp_f32 v196, v196
  v_exp_f32 v197, v197
  v_exp_f32 v198, v198
  v_mfma_f32_32x32x16_bf16 v[64:79], v[244:247], v[168:171], v[64:79]
  v_exp_f32 v199, v199
  v_exp_f32 v200, v200
  v_exp_f32 v201, v201
  v_mfma_f32_32x32x16_bf16 v[80:95], v[248:251], v[168:171], v[80:95]
  v_exp_f32 v202, v202
  v_exp_f32 v203, v203
  v_exp_f32 v204, v204
  v_mfma_f32_32x32x16_bf16 v[96:111], v[252:255], v[168:171], v[96:111]
  v_exp_f32 v205, v205
  v_exp_f32 v206, v206
  v_exp_f32 v207, v207
  v_add_u32 v2, 61440, v2
  ds_read_b64_tr_b16 v[232:233], v2 offset:6144
  ds_read_b64_tr_b16 v[234:235], v2 offset:6912
  ds_read_b64_tr_b16 v[236:237], v2 offset:6208
  ds_read_b64_tr_b16 v[238:239], v2 offset:6976
  ds_read_b64_tr_b16 v[240:241], v2 offset:6272
  ds_read_b64_tr_b16 v[242:243], v2 offset:7040
  ds_read_b64_tr_b16 v[244:245], v2 offset:9216
  ds_read_b64_tr_b16 v[246:247], v2 offset:9984
  ds_read_b64_tr_b16 v[248:249], v2 offset:9280
  ds_read_b64_tr_b16 v[250:251], v2 offset:10048
  ds_read_b64_tr_b16 v[252:253], v2 offset:9344
  ds_read_b64_tr_b16 v[254:255], v2 offset:10112
  v_pk_fma_f32 v[192:193], v[192:193], s[46:47], s[46:47]
  v_pk_fma_f32 v[194:195], v[194:195], s[46:47], s[46:47]
  v_pk_fma_f32 v[196:197], v[196:197], s[46:47], s[46:47]
  v_pk_fma_f32 v[198:199], v[198:199], s[46:47], s[46:47]
  v_pk_fma_f32 v[200:201], v[200:201], s[46:47], s[46:47]
  v_pk_fma_f32 v[202:203], v[202:203], s[46:47], s[46:47]
  v_pk_fma_f32 v[204:205], v[204:205], s[46:47], s[46:47]
  v_pk_fma_f32 v[206:207], v[206:207], s[46:47], s[46:47]
  v_rcp_f32 v192, v192
  v_rcp_f32 v193, v193
  v_rcp_f32 v194, v194
  v_rcp_f32 v195, v195
  v_rcp_f32 v196, v196
  v_rcp_f32 v197, v197
  v_rcp_f32 v198, v198
  v_rcp_f32 v199, v199
  v_rcp_f32 v200, v200
  v_rcp_f32 v201, v201
  v_rcp_f32 v202, v202
  v_rcp_f32 v203, v203
  v_rcp_f32 v204, v204
  v_rcp_f32 v205, v205
  v_mul_f32 v176, v176, v192
  v_mul_f32 v177, v177, v193
  v_rcp_f32 v206, v206
  v_rcp_f32 v207, v207
  v_mul_f32 v178, v178, v194
  v_mul_f32 v179, v179, v195
  v_mul_f32 v180, v180, v196
  v_mul_f32 v181, v181, v197
  v_pk_mul_f32 v[182:183], v[182:183], v[198:199]
  v_pk_mul_f32 v[184:185], v[184:185], v[200:201]
  v_pk_mul_f32 v[186:187], v[186:187], v[202:203]
  v_pk_mul_f32 v[188:189], v[188:189], v[204:205]
  v_pk_mul_f32 v[190:191], v[190:191], v[206:207]
  v_cvt_pk_bf16_f32 v176, v176, v177
  v_cvt_pk_bf16_f32 v177, v178, v179
  v_cvt_pk_bf16_f32 v178, v180, v181
  v_cvt_pk_bf16_f32 v179, v182, v183
  v_cvt_pk_bf16_f32 v184, v184, v185
  v_cvt_pk_bf16_f32 v185, v186, v187
  v_cvt_pk_bf16_f32 v186, v188, v189
  v_cvt_pk_bf16_f32 v187, v190, v191
  s_waitcnt lgkmcnt(0)
  v_mfma_f32_32x32x16_bf16 v[64:79], v[232:235], v[176:179], v[64:79]
  v_mfma_f32_32x32x16_bf16 v[80:95], v[236:239], v[176:179], v[80:95]
  v_mfma_f32_32x32x16_bf16 v[96:111], v[240:243], v[176:179], v[96:111]
  v_mfma_f32_32x32x16_bf16 v[64:79], v[244:247], v[184:187], v[64:79]
  v_mfma_f32_32x32x16_bf16 v[80:95], v[248:251], v[184:187], v[80:95]
  v_mfma_f32_32x32x16_bf16 v[96:111], v[252:255], v[184:187], v[96:111]
  s_nop 10
  s_bitcmp1_b32 s19, 0
  s_cbranch_scc1 L_odd
  ds_write_b128 v5, v[96:99] offset:0
  ds_write_b128 v5, v[100:103] offset:1024
  ds_write_b128 v5, v[104:107] offset:2048
  ds_write_b128 v5, v[108:111] offset:3072
  v_pk_add_f32 v[32:33], v[32:33], v[64:65]
  v_pk_add_f32 v[34:35], v[34:35], v[66:67]
  v_pk_add_f32 v[36:37], v[36:37], v[68:69]
  v_pk_add_f32 v[38:39], v[38:39], v[70:71]
  v_pk_add_f32 v[40:41], v[40:41], v[72:73]
  v_pk_add_f32 v[42:43], v[42:43], v[74:75]
  v_pk_add_f32 v[44:45], v[44:45], v[76:77]
  v_pk_add_f32 v[46:47], v[46:47], v[78:79]
  v_pk_add_f32 v[48:49], v[48:49], v[80:81]
  v_pk_add_f32 v[50:51], v[50:51], v[82:83]
  v_pk_add_f32 v[52:53], v[52:53], v[84:85]
  v_pk_add_f32 v[54:55], v[54:55], v[86:87]
  v_pk_add_f32 v[56:57], v[56:57], v[88:89]
  v_pk_add_f32 v[58:59], v[58:59], v[90:91]
  v_pk_add_f32 v[60:61], v[60:61], v[92:93]
  v_pk_add_f32 v[62:63], v[62:63], v[94:95]
  s_waitcnt lgkmcnt(0)
  s_barrier
  ds_read_b128 v[208:211], v6 offset:0
  ds_read_b128 v[212:215], v6 offset:1024
  ds_read_b128 v[216:219], v6 offset:2048
  ds_read_b128 v[220:223], v6 offset:3072
  ds_read_b128 v[224:227], v6 offset:4096
  ds_read_b128 v[228:231], v6 offset:5120
  ds_read_b128 v[232:235], v6 offset:6144
  ds_read_b128 v[236:239], v6 offset:7168
  s_waitcnt lgkmcnt(4)
  v_pk_add_f32 v[32:33], v[32:33], v[208:209]
  v_pk_add_f32 v[34:35], v[34:35], v[210:211]
  v_pk_add_f32 v[36:37], v[36:37], v[212:213]
  v_pk_add_f32 v[38:39], v[38:39], v[214:215]
  v_pk_add_f32 v[40:41], v[40:41], v[216:217]
  v_pk_add_f32 v[42:43], v[42:43], v[218:219]
  v_pk_add_f32 v[44:45], v[44:45], v[220:221]
  v_pk_add_f32 v[46:47], v[46:47], v[222:223]
  v_cvt_pk_bf16_f32 v64, v32, v33
  v_cvt_pk_bf16_f32 v65, v34, v35
  v_cvt_pk_bf16_f32 v66, v36, v37
  v_cvt_pk_bf16_f32 v67, v38, v39
  v_cvt_pk_bf16_f32 v68, v40, v41
  v_cvt_pk_bf16_f32 v69, v42, v43
  v_cvt_pk_bf16_f32 v70, v44, v45
  v_cvt_pk_bf16_f32 v71, v46, v47
  s_nop 1
  v_permlane16_swap_b32 v64, v68
  v_permlane16_swap_b32 v65, v69
  v_permlane16_swap_b32 v66, v70
  v_permlane16_swap_b32 v67, v71
  buffer_store_dwordx4 v[64:67], v15, s[8:11], s50 offen offset:0 sc1
  buffer_store_dwordx4 v[68:71], v15, s[8:11], s50 offen offset:192 sc1
  s_waitcnt lgkmcnt(0)
  v_pk_add_f32 v[48:49], v[48:49], v[224:225]
  v_pk_add_f32 v[50:51], v[50:51], v[226:227]
  v_pk_add_f32 v[52:53], v[52:53], v[228:229]
  v_pk_add_f32 v[54:55], v[54:55], v[230:231]
  v_pk_add_f32 v[56:57], v[56:57], v[232:233]
  v_pk_add_f32 v[58:59], v[58:59], v[234:235]
  v_pk_add_f32 v[60:61], v[60:61], v[236:237]
  v_pk_add_f32 v[62:63], v[62:63], v[238:239]
  v_cvt_pk_bf16_f32 v72, v48, v49
  v_cvt_pk_bf16_f32 v73, v50, v51
  v_cvt_pk_bf16_f32 v74, v52, v53
  v_cvt_pk_bf16_f32 v75, v54, v55
  v_cvt_pk_bf16_f32 v76, v56, v57
  v_cvt_pk_bf16_f32 v77, v58, v59
  v_cvt_pk_bf16_f32 v78, v60, v61
  v_cvt_pk_bf16_f32 v79, v62, v63
  s_nop 1
  v_permlane16_swap_b32 v72, v76
  v_permlane16_swap_b32 v73, v77
  v_permlane16_swap_b32 v74, v78
  v_permlane16_swap_b32 v75, v79
  buffer_store_dwordx4 v[72:75], v15, s[8:11], s50 offen offset:64 sc1
  buffer_store_dwordx4 v[76:79], v15, s[8:11], s50 offen offset:256 sc1
  s_branch L_fin
L_odd:
  ds_write_b128 v5, v[64:67] offset:0
  ds_write_b128 v5, v[68:71] offset:1024
  ds_write_b128 v5, v[72:75] offset:2048
  ds_write_b128 v5, v[76:79] offset:3072
  ds_write_b128 v5, v[80:83] offset:4096
  ds_write_b128 v5, v[84:87] offset:5120
  ds_write_b128 v5, v[88:91] offset:6144
  ds_write_b128 v5, v[92:95] offset:7168
  v_pk_add_f32 v[32:33], v[32:33], v[96:97]
  v_pk_add_f32 v[34:35], v[34:35], v[98:99]
  v_pk_add_f32 v[36:37], v[36:37], v[100:101]
  v_pk_add_f32 v[38:39], v[38:39], v[102:103]
  v_pk_add_f32 v[40:41], v[40:41], v[104:105]
  v_pk_add_f32 v[42:43], v[42:43], v[106:107]
  v_pk_add_f32 v[44:45], v[44:45], v[108:109]
  v_pk_add_f32 v[46:47], v[46:47], v[110:111]
  s_waitcnt lgkmcnt(0)
  s_barrier
  ds_read_b128 v[208:211], v6 offset:0
  ds_read_b128 v[212:215], v6 offset:1024
  ds_read_b128 v[216:219], v6 offset:2048
  ds_read_b128 v[220:223], v6 offset:3072
  s_waitcnt lgkmcnt(0)
  v_pk_add_f32 v[32:33], v[32:33], v[208:209]
  v_pk_add_f32 v[34:35], v[34:35], v[210:211]
  v_pk_add_f32 v[36:37], v[36:37], v[212:213]
  v_pk_add_f32 v[38:39], v[38:39], v[214:215]
  v_pk_add_f32 v[40:41], v[40:41], v[216:217]
  v_pk_add_f32 v[42:43], v[42:43], v[218:219]
  v_pk_add_f32 v[44:45], v[44:45], v[220:221]
  v_pk_add_f32 v[46:47], v[46:47], v[222:223]
  v_cvt_pk_bf16_f32 v64, v32, v33
  v_cvt_pk_bf16_f32 v65, v34, v35
  v_cvt_pk_bf16_f32 v66, v36, v37
  v_cvt_pk_bf16_f32 v67, v38, v39
  v_cvt_pk_bf16_f32 v68, v40, v41
  v_cvt_pk_bf16_f32 v69, v42, v43
  v_cvt_pk_bf16_f32 v70, v44, v45
  v_cvt_pk_bf16_f32 v71, v46, v47
  s_nop 1
  v_permlane16_swap_b32 v64, v68
  v_permlane16_swap_b32 v65, v69
  v_permlane16_swap_b32 v66, v70
  v_permlane16_swap_b32 v67, v71
  buffer_store_dwordx4 v[64:67], v15, s[8:11], s50 offen offset:0 sc1
  buffer_store_dwordx4 v[68:71], v15, s[8:11], s50 offen offset:192 sc1
L_fin:
L_end:
  s_endpgm
.section .rodata,"a"
.p2align 6
.amdhsa_kernel standalone__modern_conv_block_replknet__vision_kernel
  .amdhsa_next_free_vgpr 256
  .amdhsa_next_free_sgpr 102
  .amdhsa_accum_offset 256
  .amdhsa_group_segment_fixed_size 0
  .amdhsa_kernarg_size 64
  .amdhsa_user_sgpr_count 2
  .amdhsa_user_sgpr_kernarg_segment_ptr 1
  .amdhsa_system_sgpr_workgroup_id_x 1
.end_amdhsa_kernel
```
